```python
import torch

def _softmax(x, axis=-1):
    return torch.softmax(x, dim=axis)
def _gelu(x):
    return torch.nn.functional.gelu(x, approximate="tanh")
def _silu(x):
    return torch.nn.functional.silu(x)
def _sigmoid(x):
    return torch.sigmoid(x)
def _layernorm(x, axis=-1, eps=1e-5):
    m = x.mean(dim=axis, keepdim=True)
    v = x.var(dim=axis, keepdim=True, unbiased=False)
    return (x - m) / torch.sqrt(v + eps)
def _scatter_add(tgt, idx, src, axis=0):
    return tgt.clone().index_add_(axis, idx, src)
def _segment_sum(src, seg, n):
    out = torch.zeros((n,) + src.shape[1:], dtype=src.dtype)
    return out.index_add_(0, seg, src)
def _pad(x, pw):
    flat = tuple(v for pair in reversed(pw) for v in pair)
    return torch.nn.functional.pad(x, flat)

kernel_name = 'recurrent_scan__ssm_conv_s5__glu_gated_geglu__prompt'

def setup_inputs():

    _w = (lambda a: (lambda t: t.to(torch.bfloat16) if t.is_floating_point() else t)(torch.as_tensor(a)))
    def _A_setup():
        B, S, D = 1, 2048, 512
        P = D
        Lambda_re = -0.5 * (lambda _x: torch.exp(torch.as_tensor(_x)))((lambda *s: torch.randn(*s, dtype=torch.bfloat16) * 0.8)(P))
        Lambda_im = (lambda *s: torch.randn(*s, dtype=torch.bfloat16) * 0.8)(P) * 1.0
        B_re = (lambda *s: torch.randn(*s, dtype=torch.bfloat16) * 1.6)(P, D) * (D ** -0.5)
        B_im = (lambda *s: torch.randn(*s, dtype=torch.bfloat16) * 0.8)(P, D) * (D ** -0.5)
        C_re = (lambda *s: torch.randn(*s, dtype=torch.bfloat16) * 1.6)(D, P) * (P ** -0.5)
        C_im = (lambda *s: torch.randn(*s, dtype=torch.bfloat16) * 1.6)(D, P) * (P ** -0.5)
        log_dt = (lambda *s: torch.randn(*s, dtype=torch.bfloat16) * 0.8)(P) * 0.3 - 2.0
        Dskip = (lambda *s: torch.randn(*s, dtype=torch.bfloat16) * 0.8)(D)
        return {
            "x": _w((lambda *s: torch.randn(*s, dtype=torch.bfloat16) * 0.05)(B, S, D)),
            "Lambda_re": _w(Lambda_re),
            "Lambda_im": _w(Lambda_im),
            "B_re": _w(B_re),
            "B_im": _w(B_im),
            "C_re": _w(C_re),
            "C_im": _w(C_im),
            "log_dt": _w(log_dt),
            "Dskip": _w(Dskip),
        }
    _A_in = _A_setup()

    def _B_setup():
        B, S, Dm, Df = 1, 2048, 512, 1376
        return {
            "x": _w((lambda *s: torch.randn(*s, dtype=torch.bfloat16) * 0.05)(B, S, Dm)),
            "w_gate": _w((lambda *s: torch.randn(*s, dtype=torch.bfloat16) * 0.2)(Dm, Df) * (Dm ** -0.5)),
            "w_up": _w((lambda *s: torch.randn(*s, dtype=torch.bfloat16) * 0.2)(Dm, Df) * (Dm ** -0.5)),
            "w_down": _w((lambda *s: torch.randn(*s, dtype=torch.bfloat16) * 0.2)(Df, Dm) * (Df ** -0.5)),
        }
    _B_in = _B_setup()

    return {
        "A_x": _A_in["x"],
        "A_Lambda_re": _A_in["Lambda_re"],
        "A_Lambda_im": _A_in["Lambda_im"],
        "A_B_re": _A_in["B_re"],
        "A_B_im": _A_in["B_im"],
        "A_C_re": _A_in["C_re"],
        "A_C_im": _A_in["C_im"],
        "A_log_dt": _A_in["log_dt"],
        "A_Dskip": _A_in["Dskip"],
        "B_x": _B_in["x"],
        "B_w_gate": _B_in["w_gate"],
        "B_w_up": _B_in["w_up"],
        "B_w_down": _B_in["w_down"],
    }

def reference(A_x, A_Lambda_re, A_Lambda_im, A_B_re, A_B_im, A_C_re, A_C_im, A_log_dt, A_Dskip, B_x, B_w_gate, B_w_up, B_w_down):
    def _A_ref(x, Lambda_re, Lambda_im, B_re, B_im, C_re, C_im, log_dt, Dskip):
        Bsz, L, H = x.shape
        Lam = Lambda_re + 1j * Lambda_im
        Bmat = B_re + 1j * B_im
        Cmat = C_re + 1j * C_im
        dt = torch.exp(log_dt)
        Lam_bar = torch.exp(dt * Lam)
        B_bar = ((Lam_bar - 1.0) / Lam)[:, None] * Bmat
        Bu = torch.einsum("bld,pd->blp", x + 0j, B_bar)
        h = torch.zeros_like(Bu[:, 0, :])
        hs = []
        for t in range(L):
            h = Lam_bar[None, :] * h + Bu[:, t, :]
            hs.append(h)
        hseq = torch.stack(hs, 1)
        y = 2.0 * torch.einsum("blp,dp->bld", hseq, Cmat).real + x * Dskip[None, None, :]
        return y

    def _B_ref(x, w_gate, w_up, w_down):
        g = torch.einsum("bsd,df->bsf", x, w_gate)
        u = torch.einsum("bsd,df->bsf", x, w_up)
        h = _gelu(g) * u
        return torch.einsum("bsf,fd->bsd", h, w_down)

    x = A_x
    xn = _layernorm(x, axis=-1)
    s = _A_ref(xn, A_Lambda_re, A_Lambda_im, A_B_re, A_B_im, A_C_re, A_C_im, A_log_dt, A_Dskip)
    g = _silu(_B_ref(xn, B_w_gate, B_w_up, B_w_down))
    return x + s * g
```

```asm
; @launch grid=(256,1,1) block=(256,1,1) lds=163840
.amdgcn_target "amdgcn-amd-amdhsa--gfx950"
.text
.globl recurrent_scan__ssm_conv_s5__glu_gated_geglu__prompt_kernel
.p2align 8
.type recurrent_scan__ssm_conv_s5__glu_gated_geglu__prompt_kernel,@function
recurrent_scan__ssm_conv_s5__glu_gated_geglu__prompt_kernel:
    s_cmp_ge_u32 s2, 256
    s_cbranch_scc0 L_go
    s_endpgm
L_go:
    s_load_dwordx16 s[40:55], s[0:1], 0
    s_load_dwordx16 s[56:71], s[0:1], 64
    s_lshr_b32 s33, s2, 3
    s_getpc_b64 s[4:5]
L_pc:
    s_and_b32 s3, s33, 3
    s_lshl_b32 s3, s3, 13
    v_and_b32 v24, 63, v0
    v_lshl_add_u32 v24, v24, 7, s3
    v_min_u32 v24, L_codeend-L_pc-4, v24
    global_load_dword a210, v24, s[4:5]
    s_and_b32 s3, s2, 7
    s_and_b32 s24, s3, 1
    s_lshl_b32 s24, s24, 3
    s_and_b32 s34, s33, 7
    s_add_u32 s24, s24, s34
    s_lshr_b32 s25, s3, 1
    s_lshl_b32 s25, s25, 2
    s_lshr_b32 s34, s33, 3
    s_add_u32 s25, s25, s34
    s_lshr_b32 s32, s33, 2
    s_and_b32 s31, s3, 1
    s_lshl_b32 s31, s31, 1
    s_bfe_u32 s34, s3, 0x10001
    s_add_u32 s31, s31, s34
    s_lshl_b32 s31, s31, 2
    s_and_b32 s34, s33, 3
    s_add_u32 s31, s31, s34
    s_lshr_b32 s30, s3, 2
    v_lshrrev_b32 v22, 6, v0
    v_and_b32 v0, 63, v0
    v_readfirstlane_b32 s26, v22
    s_mul_i32 s28, s25, 3
    s_lshr_b32 s29, s25, 2
    s_sub_u32 s28, s28, s29
    s_cmp_eq_u32 s25, 15
    s_subb_u32 s28, s28, 0
    s_lshr_b32 s29, 0xc888, s25
    s_and_b32 s29, s29, 1
    s_sub_u32 s28, s28, s29
    v_lshlrev_b32 v15, 4, v0
    v_lshrrev_b32 v22, 3, v0
    v_and_b32 v23, 7, v0
    v_lshrrev_b32 v24, 4, v0
    v_xor_b32 v23, v23, v24
    v_lshlrev_b32 v23, 4, v23
    v_xor_b32 v24, 64, v23
    v_lshrrev_b32 v25, 2, v22
    v_lshlrev_b32 v25, 4, v25
    v_and_b32 v26, 3, v22
    v_add_u32 v25, v25, v26
    v_lshlrev_b32 v25, 10, v25
    v_add_u32 v1, v25, v23
    v_add_u32 v2, v25, v24
    v_add_u32 v3, 6144, v1
    v_add_u32 v4, 9216, v2
    v_add_u32 v2, 3072, v2
    v_lshlrev_b32 v25, 10, v22
    v_add_u32 v5, v25, v23
    v_add_u32 v6, v25, v24
    v_add_u32 v6, 7168, v6
    v_lshrrev_b32 v22, 4, v0
    v_bfe_u32 v23, v0, 2, 2
    v_and_b32 v24, 3, v0
    v_lshlrev_b32 v24, 4, v24
    v_mov_b32 v28, 0x40000000
    s_movk_i32 s33, 2752
    v_add_u32 v25, 0, v22
    v_mul_u32_u24 v26, 11, v25
    v_lshrrev_b32 v26, 5, v26
    v_mul_u32_u24 v27, 3, v26
    v_sub_u32 v27, v25, v27
    v_cmp_gt_u32 vcc, s29, v27
    v_lshl_add_u32 v26, v26, 2, v23
    v_mul_u32_u24 v26, s33, v26
    v_lshl_add_u32 v26, v27, 6, v26
    v_add_u32 v26, v26, v24
    v_cndmask_b32 v26, v26, v28, vcc
    v_subrev_u32 v7, 0, v26
    v_add_u32 v10, 40960, v26
    v_add_u32 v25, 4, v22
    v_mul_u32_u24 v26, 11, v25
    v_lshrrev_b32 v26, 5, v26
    v_mul_u32_u24 v27, 3, v26
    v_sub_u32 v27, v25, v27
    v_cmp_gt_u32 vcc, s29, v27
    v_lshl_add_u32 v26, v26, 2, v23
    v_mul_u32_u24 v26, s33, v26
    v_lshl_add_u32 v26, v27, 6, v26
    v_add_u32 v26, v26, v24
    v_cndmask_b32 v26, v26, v28, vcc
    v_subrev_u32 v8, 1024, v26
    v_add_u32 v11, 44032, v26
    v_add_u32 v25, 8, v22
    v_mul_u32_u24 v26, 11, v25
    v_lshrrev_b32 v26, 5, v26
    v_mul_u32_u24 v27, 3, v26
    v_sub_u32 v27, v25, v27
    v_cmp_gt_u32 vcc, s29, v27
    v_lshl_add_u32 v26, v26, 2, v23
    v_mul_u32_u24 v26, s33, v26
    v_lshl_add_u32 v26, v27, 6, v26
    v_add_u32 v26, v26, v24
    v_cndmask_b32 v26, v26, v28, vcc
    v_subrev_u32 v9, 2048, v26
    v_add_u32 v12, 43008, v26
    s_lshl_b32 s34, s24, 7
    s_lshl_b32 s35, s26, 5
    s_add_u32 s34, s34, s35
    s_lshl_b32 s34, s34, 10
    s_and_b32 s36, s26, 1
    s_lshl_b32 s35, s25, 1
    s_add_u32 s35, s35, s36
    s_lshl_b32 s35, s35, 14
    s_mul_i32 s36, s36, 88064
    s_lshl_b32 s37, s28, 6
    s_add_u32 s36, s36, s37
    s_lshl_b32 s37, s26, 12
    s_lshl_b32 s38, s26, 11
    s_add_u32 s38, s38, 16384
    s_mul_i32 s39, s26, 6144
    s_add_u32 s39, s39, 24576
    s_lshl_b32 s96, s26, 10
    v_and_b32 v22, 31, v0
    s_lshl_b32 s33, s25, 6
    v_lshl_add_u32 v23, v22, 1, s33
    s_add_u32 s33, s25, s24
    s_and_b32 s33, s33, 3
    s_lshl_b32 s98, s33, 8
    s_and_b32 s3, s25, 3
    s_lshl_b32 s3, s3, 5
    s_lshl_b32 s33, s24, 7
    s_add_u32 s3, s3, s33
    s_lshr_b32 s33, s25, 2
    s_lshl_b32 s33, s33, 2
    s_add_u32 s33, s33, s26
    s_lshl_b32 s33, s33, 1
    s_add_u32 s97, s33, s3
    s_lshl_b32 s99, s97, 10
    s_mov_b32 s10, 2097152
    s_mov_b32 s11, 0x00020000
    s_mov_b32 s14, 524288
    s_mov_b32 s15, 0x00020000
    s_mov_b32 s18, 1409024
    s_mov_b32 s19, 0x00020000
    s_mov_b32 s22, 0x10000000
    s_mov_b32 s23, 0x00020000
    s_mov_b32 s6, 1024
    s_mov_b32 s7, 0x00020000
    s_cmp_ge_u32 s26, 2
    s_waitcnt lgkmcnt(0)
    s_mov_b32 s8, s40
    s_mov_b32 s9, s41
    s_cselect_b32 s12, s48, s46
    s_cselect_b32 s13, s49, s47
    s_cselect_b32 s16, s62, s60
    s_cselect_b32 s17, s63, s61
    s_mov_b32 s59, s98
    s_mul_i32 s68, s59, 1376
    s_load_dword s27, s[70:71], 0
    buffer_load_dwordx4 v[100:103], v15, s[8:11], s99 offen
    buffer_load_dwordx4 v[104:107], v15, s[8:11], s99 offen offset:1024
    s_mov_b32 s4, s42
    s_mov_b32 s5, s43
    buffer_load_ushort v40, v23, s[4:7], 0 offen
    s_mov_b32 s4, s44
    s_mov_b32 s5, s45
    buffer_load_ushort v41, v23, s[4:7], 0 offen
    s_mov_b32 s4, s54
    s_mov_b32 s5, s55
    buffer_load_ushort v42, v23, s[4:7], 0 offen
    s_add_u32 m0, s37, 0
    s_add_u32 s100, s34, s59
    buffer_load_dwordx4 v1, s[8:11], s100 offen offset:0  lds
    buffer_load_dwordx4 v2, s[8:11], s100 offen offset:1024  lds
    buffer_load_dwordx4 v3, s[8:11], s100 offen offset:2048  lds
    buffer_load_dwordx4 v4, s[8:11], s100 offen offset:3072  lds
    s_add_u32 m0, s38, 0
    s_add_u32 s100, s35, s59
    buffer_load_dwordx4 v5, s[12:15], s100 offen offset:0  lds
    buffer_load_dwordx4 v6, s[12:15], s100 offen offset:1024  lds
    s_add_u32 m0, s39, 0
    s_add_u32 s100, s36, s68
    buffer_load_dwordx4 v7, s[16:19], s100 offen offset:0  lds
    buffer_load_dwordx4 v8, s[16:19], s100 offen offset:1024  lds
    buffer_load_dwordx4 v9, s[16:19], s100 offen offset:2048  lds
    buffer_load_dwordx4 v10, s[16:19], s100 offen offset:3072  lds
    s_add_u32 m0, s39, 4096
    s_add_u32 s59, s59, 128
    buffer_load_dwordx4 v11, s[16:19], s100 offen offset:0  lds
    buffer_load_dwordx4 v12, s[16:19], s100 offen offset:1024  lds
    s_and_b32 s59, s59, 1023
    s_mul_i32 s68, s59, 1376
    s_mov_b32 s20, s70
    s_mov_b32 s21, s71
    v_lshrrev_b32 v23, 5, v0
    v_bfe_u32 v24, v0, 1, 3
    v_xor_b32 v24, v24, v23
    v_lshlrev_b32 v24, 4, v24
    v_lshl_add_u32 v24, v22, 7, v24
    v_mul_u32_u24 v25, 1536, v23
    v_bfe_u32 v26, v0, 2, 2
    v_lshl_add_u32 v25, v26, 6, v25
    v_bfe_u32 v26, v0, 4, 1
    v_lshl_add_u32 v25, v26, 5, v25
    v_and_b32 v26, 3, v0
    v_lshl_add_u32 v25, v26, 3, v25
    v_xor_b32 v26, 0, v24
    v_add_u32 v68, 0, v26
    v_add_u32 v64, s37, v68
    v_xor_b32 v26, 32, v24
    v_add_u32 v69, 0, v26
    v_add_u32 v65, s37, v69
    v_xor_b32 v26, 64, v24
    v_add_u32 v70, 0, v26
    v_add_u32 v66, s37, v70
    v_xor_b32 v26, 96, v24
    v_add_u32 v71, 0, v26
    v_add_u32 v67, s37, v71
    v_add_u32 v72, 0, v25
    v_xor_b32 v26, 0, v24
    v_add_u32 v77, 49152, v26
    v_add_u32 v73, s37, v77
    v_xor_b32 v26, 32, v24
    v_add_u32 v78, 49152, v26
    v_add_u32 v74, s37, v78
    v_xor_b32 v26, 64, v24
    v_add_u32 v79, 49152, v26
    v_add_u32 v75, s37, v79
    v_xor_b32 v26, 96, v24
    v_add_u32 v80, 49152, v26
    v_add_u32 v76, s37, v80
    v_add_u32 v81, 49152, v25
    v_xor_b32 v26, 0, v24
    v_add_u32 v86, 98304, v26
    v_add_u32 v82, s37, v86
    v_xor_b32 v26, 32, v24
    v_add_u32 v87, 98304, v26
    v_add_u32 v83, s37, v87
    v_xor_b32 v26, 64, v24
    v_add_u32 v88, 98304, v26
    v_add_u32 v84, s37, v88
    v_xor_b32 v26, 96, v24
    v_add_u32 v89, 98304, v26
    v_add_u32 v85, s37, v89
    v_add_u32 v90, 98304, v25
    s_cmp_eq_u32 s30, 0
    s_cbranch_scc1 L_b2y
    s_mov_b32 s72, s64
    s_mov_b32 s73, s65
    s_mov_b32 s76, s64
    s_mov_b32 s77, s65
    s_mov_b32 s74, 1409024
    v_bfe_u32 v26, v0, 2, 2
    v_lshl_add_u32 v26, v23, 2, v26
    v_lshlrev_b32 v26, 10, v26
    v_bfe_u32 v27, v0, 4, 1
    v_lshl_add_u32 v26, v27, 6, v26
    v_and_b32 v27, 3, v0
    v_lshl_add_u32 v13, v27, 4, v26
    s_lshr_b32 s101, s32, 0
    s_mul_i32 s101, s101, 5
    s_and_b32 s33, s31, 3
    s_mul_i32 s33, s33, 11
    s_add_u32 s101, s101, s33
    s_lshr_b32 s33, s31, 2
    s_mul_i32 s33, s33, 3
    s_add_u32 s101, s101, s33
    s_and_b32 s101, s101, 0xfe
    s_sub_u32 s33, s101, 42
    s_cmp_ge_u32 s101, 42
    s_cselect_b32 s101, s33, s101
    v_add_u32 v26, s101, v0
    v_subrev_u32 v27, 42, v26
    v_cmp_lt_u32 vcc, 41, v0
    v_min_u32 v26, v26, v27
    s_lshl_b32 s33, s32, 7
    v_cndmask_b32 v26, v26, 42, vcc
    s_lshl_b32 s3, s26, 13
    s_add_u32 s33, s33, s3
    v_lshlrev_b32 v26, 15, v26
    v_add_u32 v14, s33, v26
    s_branch L_b2j
L_b2y:
    s_mov_b32 s72, s50
    s_mov_b32 s73, s51
    s_mov_b32 s76, s52
    s_mov_b32 s77, s53
    s_mov_b32 s74, 524288
    s_and_b32 s33, s26, 1
    s_lshl_b32 s33, s33, 6
    v_xor_b32 v13, s33, v5
    s_lshl_b32 s33, s31, 1
    s_and_b32 s101, s32, 7
    s_add_u32 s101, s33, s101
    s_lshr_b32 s33, s31, 2
    s_add_u32 s101, s101, s33
    s_and_b32 s101, s101, 7
    v_lshrrev_b32 v26, 2, v0
    v_add_u32 v26, s101, v26
    v_and_b32 v26, 7, v26
    v_lshlrev_b32 v26, 7, v26
    v_bfe_u32 v27, v0, 1, 1
    v_lshl_add_u32 v26, v27, 15, v26
    s_lshl_b32 s33, s32, 16
    s_lshl_b32 s3, s26, 13
    s_add_u32 s33, s33, s3
    v_add_u32 v14, s33, v26
L_b2j:
    s_mov_b32 s75, 0x00020000
    s_mov_b32 s78, s74
    s_mov_b32 s79, 0x00020000
    s_bfe_u32 s69, s24, 0x10002
    s_lshr_b32 s3, s24, 3
    s_and_b32 s47, s24, 7
    s_xor_b32 s3, s3, s25
    s_bitcmp1_b32 s3, 0
    s_cselect_b32 s69, 15, s69
    s_lshl_b32 s33, s26, 8
    s_add_u32 s33, s33, 24320
    v_add_u32 v38, s33, v72
    v_lshlrev_b32 v20, 4, v22
    s_lshl_b32 s33, s25, 3
    s_add_u32 s33, s33, s47
    s_lshl_b32 s33, s33, 2
    s_add_u32 s33, s33, s26
    s_lshl_b32 s33, s33, 9
    s_add_u32 s47, s33, 1572864
    v_mov_b32 v92, 0x3f803f80
    v_mov_b32 v93, 0x3f803f80
    v_mov_b32 v94, 0x3f803f80
    v_mov_b32 v95, 0x3f803f80
    v_accvgpr_write_b32 a73, 0
    v_accvgpr_write_b32 a75, 0
    v_accvgpr_write_b32 a77, 0
    v_accvgpr_write_b32 a79, 0
    v_accvgpr_write_b32 a81, 0
    v_accvgpr_write_b32 a83, 0
    v_accvgpr_write_b32 a85, 0
    v_accvgpr_write_b32 a87, 0
    v_accvgpr_write_b32 a89, 0
    v_accvgpr_write_b32 a88, 0
    v_accvgpr_write_b32 a120, 0
    v_accvgpr_write_b32 a121, 0
    s_waitcnt vmcnt(15)
    v_lshlrev_b32 v108, 16, v100
    v_and_b32 v109, 0xffff0000, v100
    v_lshlrev_b32 v110, 16, v101
    v_and_b32 v111, 0xffff0000, v101
    v_lshlrev_b32 v112, 16, v102
    v_and_b32 v113, 0xffff0000, v102
    v_lshlrev_b32 v114, 16, v103
    v_and_b32 v115, 0xffff0000, v103
    v_lshlrev_b32 v116, 16, v104
    v_and_b32 v117, 0xffff0000, v104
    v_lshlrev_b32 v118, 16, v105
    v_and_b32 v119, 0xffff0000, v105
    v_lshlrev_b32 v120, 16, v106
    v_and_b32 v121, 0xffff0000, v106
    v_lshlrev_b32 v122, 16, v107
    v_and_b32 v123, 0xffff0000, v107
    v_add_f32 v32, v108, v109
    v_add_f32 v33, v116, v117
    v_add_f32 v32, v32, v110
    v_add_f32 v33, v33, v118
    v_add_f32 v32, v32, v111
    v_add_f32 v33, v33, v119
    v_add_f32 v32, v32, v112
    v_add_f32 v33, v33, v120
    v_add_f32 v32, v32, v113
    v_add_f32 v33, v33, v121
    v_add_f32 v32, v32, v114
    v_add_f32 v33, v33, v122
    v_add_f32 v32, v32, v115
    v_add_f32 v33, v33, v123
    s_nop 1
    v_add_f32_dpp v32, v32, v32 row_ror:8 row_mask:0xf bank_mask:0xf
    v_add_f32_dpp v33, v33, v33 row_ror:8 row_mask:0xf bank_mask:0xf
    s_nop 1
    v_add_f32_dpp v32, v32, v32 row_ror:4 row_mask:0xf bank_mask:0xf
    v_add_f32_dpp v33, v33, v33 row_ror:4 row_mask:0xf bank_mask:0xf
    s_nop 1
    v_add_f32_dpp v32, v32, v32 row_ror:2 row_mask:0xf bank_mask:0xf
    v_add_f32_dpp v33, v33, v33 row_ror:2 row_mask:0xf bank_mask:0xf
    s_nop 1
    v_add_f32_dpp v32, v32, v32 row_ror:1 row_mask:0xf bank_mask:0xf
    v_add_f32_dpp v33, v33, v33 row_ror:1 row_mask:0xf bank_mask:0xf
    v_mov_b32 v34, v32
    v_mov_b32 v35, v33
    s_nop 1
    v_permlane16_swap_b32 v34, v32
    v_permlane16_swap_b32 v35, v33
    s_nop 1
    v_add_f32 v32, v32, v34
    v_add_f32 v33, v33, v35
    v_mov_b32 v34, v32
    v_mov_b32 v35, v33
    s_nop 1
    v_permlane32_swap_b32 v34, v32
    v_permlane32_swap_b32 v35, v33
    s_nop 1
    v_add_f32 v32, v32, v34
    v_add_f32 v33, v33, v35
    v_mul_f32 v32, 0x3b000000, v32
    v_mul_f32 v33, 0x3b000000, v33
    v_sub_f32 v30, v108, v32
    v_sub_f32 v31, v116, v33
    v_mul_f32 v36, v30, v30
    v_mul_f32 v37, v31, v31
    v_sub_f32 v30, v109, v32
    v_sub_f32 v31, v117, v33
    v_fmac_f32 v36, v30, v30
    v_fmac_f32 v37, v31, v31
    v_sub_f32 v30, v110, v32
    v_sub_f32 v31, v118, v33
    v_fmac_f32 v36, v30, v30
    v_fmac_f32 v37, v31, v31
    v_sub_f32 v30, v111, v32
    v_sub_f32 v31, v119, v33
    v_fmac_f32 v36, v30, v30
    v_fmac_f32 v37, v31, v31
    v_sub_f32 v30, v112, v32
    v_sub_f32 v31, v120, v33
    v_fmac_f32 v36, v30, v30
    v_fmac_f32 v37, v31, v31
    v_sub_f32 v30, v113, v32
    v_sub_f32 v31, v121, v33
    v_fmac_f32 v36, v30, v30
    v_fmac_f32 v37, v31, v31
    v_sub_f32 v30, v114, v32
    v_sub_f32 v31, v122, v33
    v_fmac_f32 v36, v30, v30
    v_fmac_f32 v37, v31, v31
    v_sub_f32 v30, v115, v32
    v_sub_f32 v31, v123, v33
    v_fmac_f32 v36, v30, v30
    v_fmac_f32 v37, v31, v31
    s_nop 1
    v_add_f32_dpp v36, v36, v36 row_ror:8 row_mask:0xf bank_mask:0xf
    v_add_f32_dpp v37, v37, v37 row_ror:8 row_mask:0xf bank_mask:0xf
    s_nop 1
    v_add_f32_dpp v36, v36, v36 row_ror:4 row_mask:0xf bank_mask:0xf
    v_add_f32_dpp v37, v37, v37 row_ror:4 row_mask:0xf bank_mask:0xf
    s_nop 1
    v_add_f32_dpp v36, v36, v36 row_ror:2 row_mask:0xf bank_mask:0xf
    v_add_f32_dpp v37, v37, v37 row_ror:2 row_mask:0xf bank_mask:0xf
    s_nop 1
    v_add_f32_dpp v36, v36, v36 row_ror:1 row_mask:0xf bank_mask:0xf
    v_add_f32_dpp v37, v37, v37 row_ror:1 row_mask:0xf bank_mask:0xf
    v_mov_b32 v34, v36
    v_mov_b32 v35, v37
    s_nop 1
    v_permlane16_swap_b32 v34, v36
    v_permlane16_swap_b32 v35, v37
    s_nop 1
    v_add_f32 v36, v36, v34
    v_add_f32 v37, v37, v35
    v_mov_b32 v34, v36
    v_mov_b32 v35, v37
    s_nop 1
    v_permlane32_swap_b32 v34, v36
    v_permlane32_swap_b32 v35, v37
    s_nop 1
    v_add_f32 v36, v36, v34
    v_add_f32 v37, v37, v35
    v_cmp_eq_u32 vcc, 1, v0
    s_waitcnt lgkmcnt(0)
    s_mul_i32 s27, s27, 1664525
    v_cndmask_b32 v32, v32, v33, vcc
    v_cndmask_b32 v36, v36, v37, vcc
    s_add_u32 s27, s27, 1013904223
    v_mul_f32 v36, 0x3b000000, v36
    v_cvt_pk_bf16_f32 v30, v32, v36
    v_lshlrev_b32 v16, 16, v30
    v_and_b32 v36, 0xffff0000, v30
    v_add_f32 v36, 0x3727c5ac, v36
    v_cvt_pk_bf16_f32 v36, v36, v36
    v_lshlrev_b32 v36, 16, v36
    v_sqrt_f32 v36, v36
    s_mov_b32 s46, s27
    v_cvt_pk_bf16_f32 v36, v36, v36
    v_lshlrev_b32 v18, 16, v36
    v_rcp_f32 v17, v18
    s_or_b32 s27, s27, 1
    v_mov_b32 v19, s27
    s_lshl_b32 s33, s97, 4
    s_add_u32 s33, s33, 1048576
    s_mov_b64 exec, 3
    buffer_store_dwordx4 v[16:19], v15, s[20:23], s33 offen sc1
    s_mov_b64 exec, -1
    s_waitcnt vmcnt(13)
    v_lshlrev_b32 v40, 16, v40
    v_lshlrev_b32 v41, 16, v41
    v_lshlrev_b32 v42, 16, v42
    v_mul_f32 v42, 0x3fb8aa3b, v42
    v_exp_f32 v42, v42
    s_nop 0
    v_cvt_pk_bf16_f32 v42, v42, v42
    v_lshlrev_b32 v42, 16, v42
    v_mul_f32 v26, v42, v40
    v_mul_f32 v27, v42, v41
    v_mul_f32 v26, 0x3fb8aa3b, v26
    v_mul_f32 v27, 0x3e22f983, v27
    v_exp_f32 v26, v26
    v_rndne_f32 v28, v27
    v_sub_f32 v27, v27, v28
    v_mul_f32 v28, 0.5, v27
    v_sin_f32 v27, v27
    v_sin_f32 v28, v28
    s_nop 0
    v_mul_f32 v28, v28, v28
    v_mul_f32 v28, -2.0, v28
    v_add_f32 v31, 1.0, v28
    v_mul_f32 v44, v26, v31
    v_mul_f32 v45, v26, v27
    v_add_f32 v26, -1.0, v26
    v_fma_f32 v26, v26, v31, v28
    v_mul_f32 v28, v40, v40
    v_fmac_f32 v28, v41, v41
    v_rcp_f32 v28, v28
    v_mul_f32 v50, v26, v40
    v_fmac_f32 v50, v45, v41
    v_mul_f32 v51, v45, v40
    v_fma_f32 v51, -v26, v41, v51
    v_add_f32 v28, v28, v28
    v_mul_f32 v50, v50, v28
    v_mul_f32 v40, v51, v28
    v_mul_f32 v26, v45, v45
    v_add_f32 v47, v45, v45
    v_mul_f32 v47, v47, v44
    v_fma_f32 v46, v44, v44, -v26
    v_mul_f32 v26, v47, v47
    v_add_f32 v49, v47, v47
    v_mul_f32 v49, v49, v46
    v_fma_f32 v48, v46, v46, -v26
    v_mul_f32 v26, v49, v49
    v_add_f32 v33, v49, v49
    v_mul_f32 v33, v33, v48
    v_fma_f32 v32, v48, v48, -v26
    v_mul_f32 v26, v33, v33
    v_add_f32 v47, v33, v33
    v_mul_f32 v47, v47, v32
    v_fma_f32 v46, v32, v32, -v26
    v_mul_f32 v26, v47, v47
    v_add_f32 v49, v47, v47
    v_mul_f32 v49, v49, v46
    v_fma_f32 v48, v46, v46, -v26
    v_mul_f32 v26, v49, v49
    v_add_f32 v33, v49, v49
    v_mul_f32 v33, v33, v48
    v_fma_f32 v32, v48, v48, -v26
    v_mul_f32 v26, v33, v33
    v_add_f32 v49, v33, v33
    v_mul_f32 v49, v49, v32
    v_fma_f32 v48, v32, v32, -v26
    v_mul_f32 v26, v49, v49
    v_add_f32 v59, v49, v49
    v_mul_f32 v59, v59, v48
    v_fma_f32 v58, v48, v48, -v26
    s_add_u32 m0, s37, 49152
    s_add_u32 s100, s34, s59
    buffer_load_dwordx4 v1, s[8:11], s100 offen offset:0  lds
    buffer_load_dwordx4 v2, s[8:11], s100 offen offset:1024  lds
    buffer_load_dwordx4 v3, s[8:11], s100 offen offset:2048  lds
    buffer_load_dwordx4 v4, s[8:11], s100 offen offset:3072  lds
    s_add_u32 m0, s38, 49152
    s_add_u32 s100, s35, s59
    buffer_load_dwordx4 v5, s[12:15], s100 offen offset:0  lds
    buffer_load_dwordx4 v6, s[12:15], s100 offen offset:1024  lds
    s_add_u32 m0, s39, 49152
    s_add_u32 s100, s36, s68
    buffer_load_dwordx4 v7, s[16:19], s100 offen offset:0  lds
    buffer_load_dwordx4 v8, s[16:19], s100 offen offset:1024  lds
    buffer_load_dwordx4 v9, s[16:19], s100 offen offset:2048  lds
    buffer_load_dwordx4 v10, s[16:19], s100 offen offset:3072  lds
    s_add_u32 m0, s39, 53248
    s_add_u32 s59, s59, 128
    buffer_load_dwordx4 v11, s[16:19], s100 offen offset:0  lds
    buffer_load_dwordx4 v12, s[16:19], s100 offen offset:1024  lds
    s_and_b32 s59, s59, 1023
    s_mul_i32 s68, s59, 1376
    s_waitcnt vmcnt(13)
    s_barrier
    ds_read_b128 a[0:3], v64
    ds_read_b128 a[4:7], v68 offset:16384
    ds_read_b128 a[8:11], v68 offset:20480
    ds_read_b64_tr_b16 a[12:13], v72 offset:24576
    ds_read_b64_tr_b16 a[14:15], v72 offset:25344
    ds_read_b64_tr_b16 a[16:17], v72 offset:36864
    ds_read_b64_tr_b16 a[18:19], v72 offset:37632
    ds_read_b64_tr_b16 a[20:21], v72 offset:24832
    ds_read_b64_tr_b16 a[22:23], v72 offset:25600
    ds_read_b64_tr_b16 a[24:25], v72 offset:37120
    ds_read_b64_tr_b16 a[26:27], v72 offset:37888
    ds_read_b64_tr_b16 a[28:29], v72 offset:25088
    ds_read_b64_tr_b16 a[30:31], v72 offset:25856
    ds_read_b64_tr_b16 a[32:33], v72 offset:37376
    ds_read_b64_tr_b16 a[34:35], v72 offset:38144
    s_waitcnt lgkmcnt(0)
    v_mfma_f32_32x32x16_bf16 v[128:143], a[0:3], a[4:7], 0
    ds_read_b128 a[36:39], v65
    ds_read_b128 a[40:43], v69 offset:16384
    ds_read_b128 a[44:47], v69 offset:20480
    v_mfma_f32_32x32x16_bf16 v[144:159], a[0:3], a[8:11], 0
    ds_read_b64_tr_b16 a[48:49], v72 offset:27648
    ds_read_b64_tr_b16 a[50:51], v72 offset:28416
    ds_read_b64_tr_b16 a[52:53], v72 offset:39936
    v_mfma_f32_32x32x16_bf16 v[160:175], a[12:15], a[0:3], 0
    ds_read_b64_tr_b16 a[54:55], v72 offset:40704
    ds_read_b64_tr_b16 a[56:57], v72 offset:27904
    ds_read_b64_tr_b16 a[58:59], v72 offset:28672
    s_lshl_b32 s3, s25, 14
    v_mfma_f32_32x32x16_bf16 v[176:191], a[16:19], a[0:3], 0
    ds_read_b64_tr_b16 a[60:61], v72 offset:40192
    ds_read_b64_tr_b16 a[62:63], v72 offset:40960
    ds_read_b64_tr_b16 a[64:65], v72 offset:28160
    s_lshl_b32 s33, s26, 9
    v_mfma_f32_32x32x16_bf16 v[192:207], a[20:23], a[0:3], 0
    ds_read_b64_tr_b16 a[66:67], v72 offset:28928
    ds_read_b64_tr_b16 a[68:69], v72 offset:40448
    ds_read_b64_tr_b16 a[70:71], v72 offset:41216
    s_add_u32 m0, s37, 98304
    s_add_u32 s100, s34, s59
    buffer_load_dwordx4 v1, s[8:11], s100 offen offset:0  lds
    v_mfma_f32_32x32x16_bf16 v[208:223], a[24:27], a[0:3], 0
    buffer_load_dwordx4 v2, s[8:11], s100 offen offset:1024  lds
    s_cmp_lg_u32 s69, 0
    s_cbranch_scc1 L_csx_0_0
    s_waitcnt lgkmcnt(3)
    s_cmp_eq_u32 s26, 0
    s_cbranch_scc1 L_cs0_0
    v_add_u32 v39, 0, v38
    ds_read_b64_tr_b16 a[176:177], v39 offset:0
    ds_read_b64_tr_b16 a[178:179], v39 offset:768
    ds_read_b64_tr_b16 a[180:181], v39 offset:12288
    ds_read_b64_tr_b16 a[182:183], v39 offset:13056
    ds_read_b64_tr_b16 a[184:185], v39 offset:3072
    ds_read_b64_tr_b16 a[186:187], v39 offset:3840
    ds_read_b64_tr_b16 a[188:189], v39 offset:15360
    ds_read_b64_tr_b16 a[190:191], v39 offset:16128
    ds_read_b64_tr_b16 a[192:193], v39 offset:6144
    ds_read_b64_tr_b16 a[194:195], v39 offset:6912
    ds_read_b64_tr_b16 a[196:197], v39 offset:18432
    ds_read_b64_tr_b16 a[198:199], v39 offset:19200
    s_waitcnt lgkmcnt(8)
    ds_read_b64_tr_b16 a[200:201], v39 offset:9216
    ds_read_b64_tr_b16 a[202:203], v39 offset:9984
    ds_read_b64_tr_b16 a[204:205], v39 offset:21504
    ds_read_b64_tr_b16 a[206:207], v39 offset:22272
    s_branch L_csx_0_0
L_cs0_0:
    ds_read_b128 a[176:179], v68 offset:16384
    ds_read_b128 a[180:183], v68 offset:20480
    ds_read_b128 a[184:187], v69 offset:16384
    ds_read_b128 a[188:191], v69 offset:20480
    ds_read_b128 a[192:195], v70 offset:16384
    ds_read_b128 a[196:199], v70 offset:20480
    ds_read_b128 a[200:203], v71 offset:16384
    ds_read_b128 a[204:207], v71 offset:20480
L_csx_0_0:
    v_mfma_f32_32x32x16_bf16 v[224:239], a[28:31], a[0:3], 0
    buffer_load_dwordx4 v3, s[8:11], s100 offen offset:2048  lds
    s_add_u32 s3, s3, s33
    s_add_u32 s3, s3, 1572864
    v_bfe_u32 v25, v0, 2, 1
    v_mfma_f32_32x32x16_bf16 v[240:255], a[32:35], a[0:3], 0
    buffer_load_dwordx4 v4, s[8:11], s100 offen offset:3072  lds
    v_lshlrev_b32 v25, 4, v25
    v_and_b32 v26, 3, v0
    v_add_u32 v25, v25, v26
    s_waitcnt lgkmcnt(0)
    v_mfma_f32_32x32x16_bf16 v[128:143], a[36:39], a[40:43], v[128:143]
    ds_read_b128 a[0:3], v66
    ds_read_b128 a[4:7], v70 offset:16384
    ds_read_b128 a[8:11], v70 offset:20480
    v_mfma_f32_32x32x16_bf16 v[144:159], a[36:39], a[44:47], v[144:159]
    ds_read_b64_tr_b16 a[12:13], v72 offset:30720
    ds_read_b64_tr_b16 a[14:15], v72 offset:31488
    ds_read_b64_tr_b16 a[16:17], v72 offset:43008
    v_bfe_u32 v26, v0, 3, 2
    v_mfma_f32_32x32x16_bf16 v[160:175], a[48:51], a[36:39], v[160:175]
    ds_read_b64_tr_b16 a[18:19], v72 offset:43776
    ds_read_b64_tr_b16 a[20:21], v72 offset:30976
    ds_read_b64_tr_b16 a[22:23], v72 offset:31744
    v_lshl_add_u32 v25, v26, 2, v25
    v_mfma_f32_32x32x16_bf16 v[176:191], a[52:55], a[36:39], v[176:191]
    ds_read_b64_tr_b16 a[24:25], v72 offset:43264
    ds_read_b64_tr_b16 a[26:27], v72 offset:44032
    ds_read_b64_tr_b16 a[28:29], v72 offset:31232
    v_lshlrev_b32 v37, 2, v25
    v_mfma_f32_32x32x16_bf16 v[192:207], a[56:59], a[36:39], v[192:207]
    ds_read_b64_tr_b16 a[30:31], v72 offset:32000
    ds_read_b64_tr_b16 a[32:33], v72 offset:43520
    ds_read_b64_tr_b16 a[34:35], v72 offset:44288
    s_add_u32 m0, s38, 98304
    s_add_u32 s100, s35, s59
    buffer_load_dwordx4 v5, s[12:15], s100 offen offset:0  lds
    v_mfma_f32_32x32x16_bf16 v[208:223], a[60:63], a[36:39], v[208:223]
    buffer_load_dwordx4 v6, s[12:15], s100 offen offset:1024  lds
    s_cmp_lg_u32 s69, 0
    s_cbranch_scc1 L_csx_0_1
    v_mfma_f32_32x32x16_bf16 v[96:111], v[92:95], a[176:179], 0
    v_mfma_f32_32x32x16_bf16 v[112:127], v[92:95], a[180:183], 0
    v_mfma_f32_32x32x16_bf16 v[96:111], v[92:95], a[184:187], v[96:111]
    v_mfma_f32_32x32x16_bf16 v[112:127], v[92:95], a[188:191], v[112:127]
    v_mfma_f32_32x32x16_bf16 v[96:111], v[92:95], a[192:195], v[96:111]
    v_mfma_f32_32x32x16_bf16 v[112:127], v[92:95], a[196:199], v[112:127]
    v_mfma_f32_32x32x16_bf16 v[96:111], v[92:95], a[200:203], v[96:111]
    v_mfma_f32_32x32x16_bf16 v[112:127], v[92:95], a[204:207], v[112:127]
L_csx_0_1:
    v_mfma_f32_32x32x16_bf16 v[224:239], a[64:67], a[36:39], v[224:239]
    s_add_u32 m0, s39, 98304
    s_add_u32 s100, s36, s68
    buffer_load_dwordx4 v7, s[16:19], s100 offen offset:0  lds
    v_lshlrev_b32 v25, 4, v25
    v_mfma_f32_32x32x16_bf16 v[240:255], a[68:71], a[36:39], v[240:255]
    buffer_load_dwordx4 v8, s[16:19], s100 offen offset:1024  lds
    s_lshr_b32 s33, s34, 6
    s_add_u32 s33, s33, 1048576
    v_add_u32 v25, s33, v25
    s_waitcnt lgkmcnt(0)
    v_mfma_f32_32x32x16_bf16 v[128:143], a[0:3], a[4:7], v[128:143]
    ds_read_b128 a[36:39], v67
    ds_read_b128 a[40:43], v71 offset:16384
    ds_read_b128 a[44:47], v71 offset:20480
    v_mfma_f32_32x32x16_bf16 v[144:159], a[0:3], a[8:11], v[144:159]
    ds_read_b64_tr_b16 a[48:49], v72 offset:33792
    ds_read_b64_tr_b16 a[50:51], v72 offset:34560
    ds_read_b64_tr_b16 a[52:53], v72 offset:46080
    s_lshl_b32 s33, s31, 2
    v_mfma_f32_32x32x16_bf16 v[160:175], a[12:15], a[0:3], v[160:175]
    ds_read_b64_tr_b16 a[54:55], v72 offset:46848
    ds_read_b64_tr_b16 a[56:57], v72 offset:34048
    ds_read_b64_tr_b16 a[58:59], v72 offset:34816
    s_add_u32 s33, s33, s26
    v_mfma_f32_32x32x16_bf16 v[176:191], a[16:19], a[0:3], v[176:191]
    ds_read_b64_tr_b16 a[60:61], v72 offset:46336
    ds_read_b64_tr_b16 a[62:63], v72 offset:47104
    ds_read_b64_tr_b16 a[64:65], v72 offset:34304
    s_lshl_b32 s62, s33, 15
    v_mfma_f32_32x32x16_bf16 v[192:207], a[20:23], a[0:3], v[192:207]
    ds_read_b64_tr_b16 a[66:67], v72 offset:35072
    ds_read_b64_tr_b16 a[68:69], v72 offset:46592
    ds_read_b64_tr_b16 a[70:71], v72 offset:47360
    buffer_load_dwordx4 v9, s[16:19], s100 offen offset:2048  lds
    v_mfma_f32_32x32x16_bf16 v[208:223], a[24:27], a[0:3], v[208:223]
    buffer_load_dwordx4 v10, s[16:19], s100 offen offset:3072  lds
    s_cmp_lg_u32 s69, 0
    s_cbranch_scc1 L_csx_0_2
    v_mov_b32 v97, v112
    v_mov_b32 v98, s27
    v_mov_b32 v99, s27
    s_mov_b64 exec, 0xffffffff
    buffer_store_dwordx4 v[96:99], v20, s[20:23], s47 offen sc1
    s_mov_b64 exec, -1
L_csx_0_2:
    v_mfma_f32_32x32x16_bf16 v[224:239], a[28:31], a[0:3], v[224:239]
    s_add_u32 m0, s39, 102400
    s_add_u32 s59, s59, 128
    buffer_load_dwordx4 v11, s[16:19], s100 offen offset:0  lds
    s_lshl_b32 s33, s33, 9
    v_mfma_f32_32x32x16_bf16 v[240:255], a[32:35], a[0:3], v[240:255]
    buffer_load_dwordx4 v12, s[16:19], s100 offen offset:1024  lds
    s_and_b32 s59, s59, 1023
    s_mul_i32 s68, s59, 1376
    s_add_u32 s33, s33, 1048576
    s_waitcnt lgkmcnt(0)
    v_mfma_f32_32x32x16_bf16 v[128:143], a[36:39], a[40:43], v[128:143]
    s_waitcnt vmcnt(12)
    s_barrier
    s_add_u32 m0, s37, 0
    s_add_u32 s100, s34, s59
    buffer_load_dwordx4 v1, s[8:11], s100 offen offset:0  lds
    v_mfma_f32_32x32x16_bf16 v[144:159], a[36:39], a[44:47], v[144:159]
    ds_read_b128 a[0:3], v73
    ds_read_b128 a[4:7], v77 offset:16384
    ds_read_b128 a[8:11], v77 offset:20480
    v_add_u32 v27, s33, v20
    v_mfma_f32_32x32x16_bf16 v[160:175], a[48:51], a[36:39], v[160:175]
    ds_read_b64_tr_b16 a[12:13], v81 offset:24576
    ds_read_b64_tr_b16 a[14:15], v81 offset:25344
    ds_read_b64_tr_b16 a[16:17], v81 offset:36864
    v_cmp_gt_u32 vcc, 32, v0
    v_mfma_f32_32x32x16_bf16 v[176:191], a[52:55], a[36:39], v[176:191]
    ds_read_b64_tr_b16 a[18:19], v81 offset:37632
    ds_read_b64_tr_b16 a[20:21], v81 offset:24832
    ds_read_b64_tr_b16 a[22:23], v81 offset:25600
    v_lshrrev_b32 v26, 5, v0
    v_mfma_f32_32x32x16_bf16 v[192:207], a[56:59], a[36:39], v[192:207]
    ds_read_b64_tr_b16 a[24:25], v81 offset:37120
    ds_read_b64_tr_b16 a[26:27], v81 offset:37888
    ds_read_b64_tr_b16 a[28:29], v81 offset:25088
    v_lshl_add_u32 v33, v26, 11, v20
    v_mfma_f32_32x32x16_bf16 v[208:223], a[60:63], a[36:39], v[208:223]
    ds_read_b64_tr_b16 a[30:31], v81 offset:25856
    ds_read_b64_tr_b16 a[32:33], v81 offset:37376
    ds_read_b64_tr_b16 a[34:35], v81 offset:38144
    v_cndmask_b32 v25, v27, v25, vcc
    v_mfma_f32_32x32x16_bf16 v[224:239], a[64:67], a[36:39], v[224:239]
    buffer_load_dwordx4 v2, s[8:11], s100 offen offset:1024  lds
    s_lshl_b32 s33, s26, 8
    s_add_u32 s33, s33, 147456
    v_and_b32 v32, 31, v0
    v_mfma_f32_32x32x16_bf16 v[240:255], a[68:71], a[36:39], v[240:255]
    buffer_load_dwordx4 v3, s[8:11], s100 offen offset:2048  lds
    v_lshl_add_u32 v32, v32, 2, s33
    s_lshl_b32 s33, s26, 7
    s_add_u32 s33, s33, 150528
    s_waitcnt lgkmcnt(0)
    v_mfma_f32_32x32x16_bf16 v[128:143], a[0:3], a[4:7], v[128:143]
    ds_read_b128 a[36:39], v74
    ds_read_b128 a[40:43], v78 offset:16384
    ds_read_b128 a[44:47], v78 offset:20480
    v_mfma_f32_32x32x16_bf16 v[144:159], a[0:3], a[8:11], v[144:159]
    ds_read_b64_tr_b16 a[48:49], v81 offset:27648
    ds_read_b64_tr_b16 a[50:51], v81 offset:28416
    ds_read_b64_tr_b16 a[52:53], v81 offset:39936
    v_add_u32 v37, s33, v37
    v_mfma_f32_32x32x16_bf16 v[160:175], a[12:15], a[0:3], v[160:175]
    ds_read_b64_tr_b16 a[54:55], v81 offset:40704
    ds_read_b64_tr_b16 a[56:57], v81 offset:27904
    ds_read_b64_tr_b16 a[58:59], v81 offset:28672
    v_lshl_add_u32 v29, v26, 6, s33
    v_mfma_f32_32x32x16_bf16 v[176:191], a[16:19], a[0:3], v[176:191]
    ds_read_b64_tr_b16 a[60:61], v81 offset:40192
    ds_read_b64_tr_b16 a[62:63], v81 offset:40960
    ds_read_b64_tr_b16 a[64:65], v81 offset:28160
    v_and_b32 v28, 31, v0
    v_mfma_f32_32x32x16_bf16 v[192:207], a[20:23], a[0:3], v[192:207]
    ds_read_b64_tr_b16 a[66:67], v81 offset:28928
    ds_read_b64_tr_b16 a[68:69], v81 offset:40448
    ds_read_b64_tr_b16 a[70:71], v81 offset:41216
    v_lshlrev_b32 v28, 2, v28
    v_mfma_f32_32x32x16_bf16 v[208:223], a[24:27], a[0:3], v[208:223]
    buffer_load_dwordx4 v4, s[8:11], s100 offen offset:3072  lds
    s_cmp_lg_u32 s69, 1
    s_cbranch_scc1 L_csx_1_0
    s_waitcnt lgkmcnt(3)
    s_cmp_eq_u32 s26, 0
    s_cbranch_scc1 L_cs0_1
    v_add_u32 v39, 49152, v38
    ds_read_b64_tr_b16 a[176:177], v39 offset:0
    ds_read_b64_tr_b16 a[178:179], v39 offset:768
    ds_read_b64_tr_b16 a[180:181], v39 offset:12288
    ds_read_b64_tr_b16 a[182:183], v39 offset:13056
    ds_read_b64_tr_b16 a[184:185], v39 offset:3072
    ds_read_b64_tr_b16 a[186:187], v39 offset:3840
    ds_read_b64_tr_b16 a[188:189], v39 offset:15360
    ds_read_b64_tr_b16 a[190:191], v39 offset:16128
    ds_read_b64_tr_b16 a[192:193], v39 offset:6144
    ds_read_b64_tr_b16 a[194:195], v39 offset:6912
    ds_read_b64_tr_b16 a[196:197], v39 offset:18432
    ds_read_b64_tr_b16 a[198:199], v39 offset:19200
    s_waitcnt lgkmcnt(8)
    ds_read_b64_tr_b16 a[200:201], v39 offset:9216
    ds_read_b64_tr_b16 a[202:203], v39 offset:9984
    ds_read_b64_tr_b16 a[204:205], v39 offset:21504
    ds_read_b64_tr_b16 a[206:207], v39 offset:22272
    s_branch L_csx_1_0
L_cs0_1:
    ds_read_b128 a[176:179], v77 offset:16384
    ds_read_b128 a[180:183], v77 offset:20480
    ds_read_b128 a[184:187], v78 offset:16384
    ds_read_b128 a[188:191], v78 offset:20480
    ds_read_b128 a[192:195], v79 offset:16384
    ds_read_b128 a[196:199], v79 offset:20480
    ds_read_b128 a[200:203], v80 offset:16384
    ds_read_b128 a[204:207], v80 offset:20480
L_csx_1_0:
    v_mfma_f32_32x32x16_bf16 v[224:239], a[28:31], a[0:3], v[224:239]
    s_add_u32 m0, s38, 0
    s_add_u32 s100, s35, s59
    buffer_load_dwordx4 v5, s[12:15], s100 offen offset:0  lds
    v_add_u32 v28, 147456, v28
    v_mfma_f32_32x32x16_bf16 v[240:255], a[32:35], a[0:3], v[240:255]
    buffer_load_dwordx4 v6, s[12:15], s100 offen offset:1024  lds
    s_lshl_b32 s63, s32, 7
    s_add_u32 s62, s62, s63
    v_lshrrev_b32 v34, 3, v0
    s_waitcnt lgkmcnt(0)
    v_mfma_f32_32x32x16_bf16 v[128:143], a[36:39], a[40:43], v[128:143]
    ds_read_b128 a[0:3], v75
    ds_read_b128 a[4:7], v79 offset:16384
    ds_read_b128 a[8:11], v79 offset:20480
    v_mfma_f32_32x32x16_bf16 v[144:159], a[36:39], a[44:47], v[144:159]
    ds_read_b64_tr_b16 a[12:13], v81 offset:30720
    ds_read_b64_tr_b16 a[14:15], v81 offset:31488
    ds_read_b64_tr_b16 a[16:17], v81 offset:43008
    v_and_b32 v35, 7, v0
    v_mfma_f32_32x32x16_bf16 v[160:175], a[48:51], a[36:39], v[160:175]
    ds_read_b64_tr_b16 a[18:19], v81 offset:43776
    ds_read_b64_tr_b16 a[20:21], v81 offset:30976
    ds_read_b64_tr_b16 a[22:23], v81 offset:31744
    v_lshlrev_b32 v35, 4, v35
    v_mfma_f32_32x32x16_bf16 v[176:191], a[52:55], a[36:39], v[176:191]
    ds_read_b64_tr_b16 a[24:25], v81 offset:43264
    ds_read_b64_tr_b16 a[26:27], v81 offset:44032
    ds_read_b64_tr_b16 a[28:29], v81 offset:31232
    v_lshl_add_u32 v34, v34, 10, v35
    v_mfma_f32_32x32x16_bf16 v[192:207], a[56:59], a[36:39], v[192:207]
    ds_read_b64_tr_b16 a[30:31], v81 offset:32000
    ds_read_b64_tr_b16 a[32:33], v81 offset:43520
    ds_read_b64_tr_b16 a[34:35], v81 offset:44288
    v_and_b32 v35, 31, v0
    v_mfma_f32_32x32x16_bf16 v[208:223], a[60:63], a[36:39], v[208:223]
    s_add_u32 m0, s39, 0
    s_add_u32 s100, s36, s68
    buffer_load_dwordx4 v7, s[16:19], s100 offen offset:0  lds
    s_cmp_lg_u32 s69, 1
    s_cbranch_scc1 L_csx_1_1
    v_mfma_f32_32x32x16_bf16 v[96:111], v[92:95], a[176:179], 0
    v_mfma_f32_32x32x16_bf16 v[112:127], v[92:95], a[180:183], 0
    v_mfma_f32_32x32x16_bf16 v[96:111], v[92:95], a[184:187], v[96:111]
    v_mfma_f32_32x32x16_bf16 v[112:127], v[92:95], a[188:191], v[112:127]
    v_mfma_f32_32x32x16_bf16 v[96:111], v[92:95], a[192:195], v[96:111]
    v_mfma_f32_32x32x16_bf16 v[112:127], v[92:95], a[196:199], v[112:127]
    v_mfma_f32_32x32x16_bf16 v[96:111], v[92:95], a[200:203], v[96:111]
    v_mfma_f32_32x32x16_bf16 v[112:127], v[92:95], a[204:207], v[112:127]
L_csx_1_1:
    v_mfma_f32_32x32x16_bf16 v[224:239], a[64:67], a[36:39], v[224:239]
    buffer_load_dwordx4 v8, s[16:19], s100 offen offset:1024  lds
    v_lshlrev_b32 v35, 1, v35
    s_mov_b32 s4, s56
    s_mov_b32 s5, s57
    v_mfma_f32_32x32x16_bf16 v[240:255], a[68:71], a[36:39], v[240:255]
    buffer_load_dwordx4 v9, s[16:19], s100 offen offset:2048  lds
    s_waitcnt lgkmcnt(0)
    v_mfma_f32_32x32x16_bf16 v[128:143], a[0:3], a[4:7], v[128:143]
    ds_read_b128 a[36:39], v76
    ds_read_b128 a[40:43], v80 offset:16384
    ds_read_b128 a[44:47], v80 offset:20480
    v_mfma_f32_32x32x16_bf16 v[144:159], a[0:3], a[8:11], v[144:159]
    ds_read_b64_tr_b16 a[48:49], v81 offset:33792
    ds_read_b64_tr_b16 a[50:51], v81 offset:34560
    ds_read_b64_tr_b16 a[52:53], v81 offset:46080
    v_mfma_f32_32x32x16_bf16 v[160:175], a[12:15], a[0:3], v[160:175]
    ds_read_b64_tr_b16 a[54:55], v81 offset:46848
    ds_read_b64_tr_b16 a[56:57], v81 offset:34048
    ds_read_b64_tr_b16 a[58:59], v81 offset:34816
    v_mfma_f32_32x32x16_bf16 v[176:191], a[16:19], a[0:3], v[176:191]
    ds_read_b64_tr_b16 a[60:61], v81 offset:46336
    ds_read_b64_tr_b16 a[62:63], v81 offset:47104
    ds_read_b64_tr_b16 a[64:65], v81 offset:34304
    v_mfma_f32_32x32x16_bf16 v[192:207], a[20:23], a[0:3], v[192:207]
    ds_read_b64_tr_b16 a[66:67], v81 offset:35072
    ds_read_b64_tr_b16 a[68:69], v81 offset:46592
    ds_read_b64_tr_b16 a[70:71], v81 offset:47360
    v_mfma_f32_32x32x16_bf16 v[208:223], a[24:27], a[0:3], v[208:223]
    buffer_load_dwordx4 v10, s[16:19], s100 offen offset:3072  lds
    s_cmp_lg_u32 s69, 1
    s_cbranch_scc1 L_csx_1_2
    v_mov_b32 v97, v112
    v_mov_b32 v98, s27
    v_mov_b32 v99, s27
    s_mov_b64 exec, 0xffffffff
    buffer_store_dwordx4 v[96:99], v20, s[20:23], s47 offen sc1
    s_mov_b64 exec, -1
L_csx_1_2:
    v_mfma_f32_32x32x16_bf16 v[224:239], a[28:31], a[0:3], v[224:239]
    s_add_u32 m0, s39, 4096
    s_add_u32 s59, s59, 128
    buffer_load_dwordx4 v11, s[16:19], s100 offen offset:0  lds
    v_mfma_f32_32x32x16_bf16 v[240:255], a[32:35], a[0:3], v[240:255]
    buffer_load_dwordx4 v12, s[16:19], s100 offen offset:1024  lds
    s_and_b32 s59, s59, 1023
    s_mul_i32 s68, s59, 1376
    s_waitcnt lgkmcnt(0)
    v_mfma_f32_32x32x16_bf16 v[128:143], a[36:39], a[40:43], v[128:143]
    s_waitcnt vmcnt(12)
    s_barrier
    s_add_u32 m0, s37, 49152
    s_add_u32 s100, s34, s59
    buffer_load_dwordx4 v1, s[8:11], s100 offen offset:0  lds
    v_mfma_f32_32x32x16_bf16 v[144:159], a[36:39], a[44:47], v[144:159]
    ds_read_b128 a[0:3], v82
    ds_read_b128 a[4:7], v86 offset:16384
    ds_read_b128 a[8:11], v86 offset:20480
    v_mfma_f32_32x32x16_bf16 v[160:175], a[48:51], a[36:39], v[160:175]
    ds_read_b64_tr_b16 a[12:13], v90 offset:24576
    ds_read_b64_tr_b16 a[14:15], v90 offset:25344
    ds_read_b64_tr_b16 a[16:17], v90 offset:36864
    v_mfma_f32_32x32x16_bf16 v[176:191], a[52:55], a[36:39], v[176:191]
    ds_read_b64_tr_b16 a[18:19], v90 offset:37632
    ds_read_b64_tr_b16 a[20:21], v90 offset:24832
    ds_read_b64_tr_b16 a[22:23], v90 offset:25600
    v_mfma_f32_32x32x16_bf16 v[192:207], a[56:59], a[36:39], v[192:207]
    ds_read_b64_tr_b16 a[24:25], v90 offset:37120
    ds_read_b64_tr_b16 a[26:27], v90 offset:37888
    ds_read_b64_tr_b16 a[28:29], v90 offset:25088
    v_mfma_f32_32x32x16_bf16 v[208:223], a[60:63], a[36:39], v[208:223]
    ds_read_b64_tr_b16 a[30:31], v90 offset:25856
    ds_read_b64_tr_b16 a[32:33], v90 offset:37376
    ds_read_b64_tr_b16 a[34:35], v90 offset:38144
    v_mfma_f32_32x32x16_bf16 v[224:239], a[64:67], a[36:39], v[224:239]
    buffer_load_dwordx4 v2, s[8:11], s100 offen offset:1024  lds
    v_mfma_f32_32x32x16_bf16 v[240:255], a[68:71], a[36:39], v[240:255]
    buffer_load_dwordx4 v3, s[8:11], s100 offen offset:2048  lds
    s_waitcnt lgkmcnt(0)
    v_mfma_f32_32x32x16_bf16 v[128:143], a[0:3], a[4:7], v[128:143]
    ds_read_b128 a[36:39], v83
    ds_read_b128 a[40:43], v87 offset:16384
    ds_read_b128 a[44:47], v87 offset:20480
    v_mfma_f32_32x32x16_bf16 v[144:159], a[0:3], a[8:11], v[144:159]
    ds_read_b64_tr_b16 a[48:49], v90 offset:27648
    ds_read_b64_tr_b16 a[50:51], v90 offset:28416
    ds_read_b64_tr_b16 a[52:53], v90 offset:39936
    v_mfma_f32_32x32x16_bf16 v[160:175], a[12:15], a[0:3], v[160:175]
    ds_read_b64_tr_b16 a[54:55], v90 offset:40704
    ds_read_b64_tr_b16 a[56:57], v90 offset:27904
    ds_read_b64_tr_b16 a[58:59], v90 offset:28672
    v_mov_b32 v93, 0
    v_mfma_f32_32x32x16_bf16 v[176:191], a[16:19], a[0:3], v[176:191]
    ds_read_b64_tr_b16 a[60:61], v90 offset:40192
    ds_read_b64_tr_b16 a[62:63], v90 offset:40960
    ds_read_b64_tr_b16 a[64:65], v90 offset:28160
    v_mov_b32 v94, 0
    v_mfma_f32_32x32x16_bf16 v[192:207], a[20:23], a[0:3], v[192:207]
    ds_read_b64_tr_b16 a[66:67], v90 offset:28928
    ds_read_b64_tr_b16 a[68:69], v90 offset:40448
    ds_read_b64_tr_b16 a[70:71], v90 offset:41216
    v_mov_b32 v95, 0
    v_mfma_f32_32x32x16_bf16 v[208:223], a[24:27], a[0:3], v[208:223]
    buffer_load_dwordx4 v4, s[8:11], s100 offen offset:3072  lds
    v_mfma_f32_32x32x16_bf16 v[224:239], a[28:31], a[0:3], v[224:239]
    s_add_u32 m0, s38, 49152
    s_add_u32 s100, s35, s59
    buffer_load_dwordx4 v5, s[12:15], s100 offen offset:0  lds
    v_mfma_f32_32x32x16_bf16 v[240:255], a[32:35], a[0:3], v[240:255]
    buffer_load_dwordx4 v6, s[12:15], s100 offen offset:1024  lds
    s_waitcnt lgkmcnt(0)
    v_mfma_f32_32x32x16_bf16 v[128:143], a[36:39], a[40:43], v[128:143]
    ds_read_b128 a[0:3], v84
    ds_read_b128 a[4:7], v88 offset:16384
    ds_read_b128 a[8:11], v88 offset:20480
    v_mfma_f32_32x32x16_bf16 v[144:159], a[36:39], a[44:47], v[144:159]
    ds_read_b64_tr_b16 a[12:13], v90 offset:30720
    ds_read_b64_tr_b16 a[14:15], v90 offset:31488
    ds_read_b64_tr_b16 a[16:17], v90 offset:43008
    v_mfma_f32_32x32x16_bf16 v[160:175], a[48:51], a[36:39], v[160:175]
    ds_read_b64_tr_b16 a[18:19], v90 offset:43776
    ds_read_b64_tr_b16 a[20:21], v90 offset:30976
    ds_read_b64_tr_b16 a[22:23], v90 offset:31744
    v_mfma_f32_32x32x16_bf16 v[176:191], a[52:55], a[36:39], v[176:191]
    ds_read_b64_tr_b16 a[24:25], v90 offset:43264
    ds_read_b64_tr_b16 a[26:27], v90 offset:44032
    ds_read_b64_tr_b16 a[28:29], v90 offset:31232
    v_mfma_f32_32x32x16_bf16 v[192:207], a[56:59], a[36:39], v[192:207]
    ds_read_b64_tr_b16 a[30:31], v90 offset:32000
    ds_read_b64_tr_b16 a[32:33], v90 offset:43520
    ds_read_b64_tr_b16 a[34:35], v90 offset:44288
    v_mfma_f32_32x32x16_bf16 v[208:223], a[60:63], a[36:39], v[208:223]
    s_add_u32 m0, s39, 49152
    s_add_u32 s100, s36, s68
    buffer_load_dwordx4 v7, s[16:19], s100 offen offset:0  lds
    v_mfma_f32_32x32x16_bf16 v[224:239], a[64:67], a[36:39], v[224:239]
    buffer_load_dwordx4 v8, s[16:19], s100 offen offset:1024  lds
    v_mfma_f32_32x32x16_bf16 v[240:255], a[68:71], a[36:39], v[240:255]
    buffer_load_dwordx4 v9, s[16:19], s100 offen offset:2048  lds
    s_waitcnt lgkmcnt(0)
    v_mfma_f32_32x32x16_bf16 v[128:143], a[0:3], a[4:7], v[128:143]
    ds_read_b128 a[36:39], v85
    ds_read_b128 a[40:43], v89 offset:16384
    ds_read_b128 a[44:47], v89 offset:20480
    v_mfma_f32_32x32x16_bf16 v[144:159], a[0:3], a[8:11], v[144:159]
    ds_read_b64_tr_b16 a[48:49], v90 offset:33792
    ds_read_b64_tr_b16 a[50:51], v90 offset:34560
    ds_read_b64_tr_b16 a[52:53], v90 offset:46080
    v_mfma_f32_32x32x16_bf16 v[160:175], a[12:15], a[0:3], v[160:175]
    ds_read_b64_tr_b16 a[54:55], v90 offset:46848
    ds_read_b64_tr_b16 a[56:57], v90 offset:34048
    ds_read_b64_tr_b16 a[58:59], v90 offset:34816
    v_mfma_f32_32x32x16_bf16 v[176:191], a[16:19], a[0:3], v[176:191]
    ds_read_b64_tr_b16 a[60:61], v90 offset:46336
    ds_read_b64_tr_b16 a[62:63], v90 offset:47104
    ds_read_b64_tr_b16 a[64:65], v90 offset:34304
    v_mfma_f32_32x32x16_bf16 v[192:207], a[20:23], a[0:3], v[192:207]
    ds_read_b64_tr_b16 a[66:67], v90 offset:35072
    ds_read_b64_tr_b16 a[68:69], v90 offset:46592
    ds_read_b64_tr_b16 a[70:71], v90 offset:47360
    v_mfma_f32_32x32x16_bf16 v[208:223], a[24:27], a[0:3], v[208:223]
    buffer_load_dwordx4 v10, s[16:19], s100 offen offset:3072  lds
    s_add_u32 s33, s62, 0
    buffer_load_dwordx4 a[104:107], v34, s[8:11], s33 offen
    v_mfma_f32_32x32x16_bf16 v[224:239], a[28:31], a[0:3], v[224:239]
    s_add_u32 m0, s39, 53248
    s_add_u32 s59, s59, 128
    buffer_load_dwordx4 v11, s[16:19], s100 offen offset:0  lds
    v_mfma_f32_32x32x16_bf16 v[240:255], a[32:35], a[0:3], v[240:255]
    buffer_load_dwordx4 v12, s[16:19], s100 offen offset:1024  lds
    s_and_b32 s59, s59, 1023
    s_mul_i32 s68, s59, 1376
    s_waitcnt lgkmcnt(0)
    v_mfma_f32_32x32x16_bf16 v[128:143], a[36:39], a[40:43], v[128:143]
    s_waitcnt vmcnt(13)
    s_barrier
    s_add_u32 m0, s37, 98304
    s_add_u32 s100, s34, s59
    buffer_load_dwordx4 v1, s[8:11], s100 offen offset:0  lds
    v_mfma_f32_32x32x16_bf16 v[144:159], a[36:39], a[44:47], v[144:159]
    ds_read_b128 a[0:3], v64
    ds_read_b128 a[4:7], v68 offset:16384
    ds_read_b128 a[8:11], v68 offset:20480
    v_mfma_f32_32x32x16_bf16 v[160:175], a[48:51], a[36:39], v[160:175]
    ds_read_b64_tr_b16 a[12:13], v72 offset:24576
    ds_read_b64_tr_b16 a[14:15], v72 offset:25344
    ds_read_b64_tr_b16 a[16:17], v72 offset:36864
    v_mfma_f32_32x32x16_bf16 v[176:191], a[52:55], a[36:39], v[176:191]
    ds_read_b64_tr_b16 a[18:19], v72 offset:37632
    ds_read_b64_tr_b16 a[20:21], v72 offset:24832
    ds_read_b64_tr_b16 a[22:23], v72 offset:25600
    v_mfma_f32_32x32x16_bf16 v[192:207], a[56:59], a[36:39], v[192:207]
    ds_read_b64_tr_b16 a[24:25], v72 offset:37120
    ds_read_b64_tr_b16 a[26:27], v72 offset:37888
    ds_read_b64_tr_b16 a[28:29], v72 offset:25088
    v_mfma_f32_32x32x16_bf16 v[208:223], a[60:63], a[36:39], v[208:223]
    ds_read_b64_tr_b16 a[30:31], v72 offset:25856
    ds_read_b64_tr_b16 a[32:33], v72 offset:37376
    ds_read_b64_tr_b16 a[34:35], v72 offset:38144
    v_mfma_f32_32x32x16_bf16 v[224:239], a[64:67], a[36:39], v[224:239]
    buffer_load_dwordx4 v2, s[8:11], s100 offen offset:1024  lds
    s_add_u32 s33, s62, 8192
    buffer_load_dwordx4 a[108:111], v34, s[8:11], s33 offen
    v_mfma_f32_32x32x16_bf16 v[240:255], a[68:71], a[36:39], v[240:255]
    buffer_load_dwordx4 v3, s[8:11], s100 offen offset:2048  lds
    s_add_u32 s33, s62, 16384
    buffer_load_dwordx4 a[112:115], v34, s[8:11], s33 offen
    s_waitcnt lgkmcnt(0)
    v_mfma_f32_32x32x16_bf16 v[128:143], a[0:3], a[4:7], v[128:143]
    ds_read_b128 a[36:39], v65
    ds_read_b128 a[40:43], v69 offset:16384
    ds_read_b128 a[44:47], v69 offset:20480
    v_mfma_f32_32x32x16_bf16 v[144:159], a[0:3], a[8:11], v[144:159]
    ds_read_b64_tr_b16 a[48:49], v72 offset:27648
    ds_read_b64_tr_b16 a[50:51], v72 offset:28416
    ds_read_b64_tr_b16 a[52:53], v72 offset:39936
    v_mfma_f32_32x32x16_bf16 v[160:175], a[12:15], a[0:3], v[160:175]
    ds_read_b64_tr_b16 a[54:55], v72 offset:40704
    ds_read_b64_tr_b16 a[56:57], v72 offset:27904
    ds_read_b64_tr_b16 a[58:59], v72 offset:28672
    v_mfma_f32_32x32x16_bf16 v[176:191], a[16:19], a[0:3], v[176:191]
    ds_read_b64_tr_b16 a[60:61], v72 offset:40192
    ds_read_b64_tr_b16 a[62:63], v72 offset:40960
    ds_read_b64_tr_b16 a[64:65], v72 offset:28160
    v_mfma_f32_32x32x16_bf16 v[192:207], a[20:23], a[0:3], v[192:207]
    ds_read_b64_tr_b16 a[66:67], v72 offset:28928
    ds_read_b64_tr_b16 a[68:69], v72 offset:40448
    ds_read_b64_tr_b16 a[70:71], v72 offset:41216
    v_mfma_f32_32x32x16_bf16 v[208:223], a[24:27], a[0:3], v[208:223]
    buffer_load_dwordx4 v4, s[8:11], s100 offen offset:3072  lds
    s_add_u32 s33, s62, 24576
    buffer_load_dwordx4 a[116:119], v34, s[8:11], s33 offen
    buffer_load_short_d16_hi a120, v35, s[4:7], s63 offen
    v_mfma_f32_32x32x16_bf16 v[224:239], a[28:31], a[0:3], v[224:239]
    s_add_u32 m0, s38, 98304
    s_add_u32 s100, s35, s59
    buffer_load_dwordx4 v5, s[12:15], s100 offen offset:0  lds
    buffer_load_short_d16_hi a121, v35, s[4:7], s63 offen offset:64
    v_mfma_f32_32x32x16_bf16 v[240:255], a[32:35], a[0:3], v[240:255]
    buffer_load_dwordx4 v6, s[12:15], s100 offen offset:1024  lds
    s_waitcnt lgkmcnt(0)
    v_mfma_f32_32x32x16_bf16 v[128:143], a[36:39], a[40:43], v[128:143]
    ds_read_b128 a[0:3], v66
    ds_read_b128 a[4:7], v70 offset:16384
    ds_read_b128 a[8:11], v70 offset:20480
    v_mfma_f32_32x32x16_bf16 v[144:159], a[36:39], a[44:47], v[144:159]
    ds_read_b64_tr_b16 a[12:13], v72 offset:30720
    ds_read_b64_tr_b16 a[14:15], v72 offset:31488
    ds_read_b64_tr_b16 a[16:17], v72 offset:43008
    v_mfma_f32_32x32x16_bf16 v[160:175], a[48:51], a[36:39], v[160:175]
    ds_read_b64_tr_b16 a[18:19], v72 offset:43776
    ds_read_b64_tr_b16 a[20:21], v72 offset:30976
    ds_read_b64_tr_b16 a[22:23], v72 offset:31744
    v_mfma_f32_32x32x16_bf16 v[176:191], a[52:55], a[36:39], v[176:191]
    ds_read_b64_tr_b16 a[24:25], v72 offset:43264
    ds_read_b64_tr_b16 a[26:27], v72 offset:44032
    ds_read_b64_tr_b16 a[28:29], v72 offset:31232
    v_mfma_f32_32x32x16_bf16 v[192:207], a[56:59], a[36:39], v[192:207]
    ds_read_b64_tr_b16 a[30:31], v72 offset:32000
    ds_read_b64_tr_b16 a[32:33], v72 offset:43520
    ds_read_b64_tr_b16 a[34:35], v72 offset:44288
    v_mfma_f32_32x32x16_bf16 v[208:223], a[60:63], a[36:39], v[208:223]
    s_add_u32 m0, s39, 98304
    s_add_u32 s100, s36, s68
    buffer_load_dwordx4 v7, s[16:19], s100 offen offset:0  lds
    v_mfma_f32_32x32x16_bf16 v[224:239], a[64:67], a[36:39], v[224:239]
    buffer_load_dwordx4 v8, s[16:19], s100 offen offset:1024  lds
    v_mfma_f32_32x32x16_bf16 v[240:255], a[68:71], a[36:39], v[240:255]
    buffer_load_dwordx4 v9, s[16:19], s100 offen offset:2048  lds
    s_waitcnt lgkmcnt(0)
    v_mfma_f32_32x32x16_bf16 v[128:143], a[0:3], a[4:7], v[128:143]
    ds_read_b128 a[36:39], v67
    ds_read_b128 a[40:43], v71 offset:16384
    ds_read_b128 a[44:47], v71 offset:20480
    v_mfma_f32_32x32x16_bf16 v[144:159], a[0:3], a[8:11], v[144:159]
    ds_read_b64_tr_b16 a[48:49], v72 offset:33792
    ds_read_b64_tr_b16 a[50:51], v72 offset:34560
    ds_read_b64_tr_b16 a[52:53], v72 offset:46080
    v_mfma_f32_32x32x16_bf16 v[160:175], a[12:15], a[0:3], v[160:175]
    ds_read_b64_tr_b16 a[54:55], v72 offset:46848
    ds_read_b64_tr_b16 a[56:57], v72 offset:34048
    ds_read_b64_tr_b16 a[58:59], v72 offset:34816
    v_mfma_f32_32x32x16_bf16 v[176:191], a[16:19], a[0:3], v[176:191]
    ds_read_b64_tr_b16 a[60:61], v72 offset:46336
    ds_read_b64_tr_b16 a[62:63], v72 offset:47104
    ds_read_b64_tr_b16 a[64:65], v72 offset:34304
    v_mfma_f32_32x32x16_bf16 v[192:207], a[20:23], a[0:3], v[192:207]
    ds_read_b64_tr_b16 a[66:67], v72 offset:35072
    ds_read_b64_tr_b16 a[68:69], v72 offset:46592
    ds_read_b64_tr_b16 a[70:71], v72 offset:47360
    v_mfma_f32_32x32x16_bf16 v[208:223], a[24:27], a[0:3], v[208:223]
    buffer_load_dwordx4 v10, s[16:19], s100 offen offset:3072  lds
    v_mfma_f32_32x32x16_bf16 v[224:239], a[28:31], a[0:3], v[224:239]
    s_add_u32 m0, s39, 102400
    s_add_u32 s59, s59, 128
    buffer_load_dwordx4 v11, s[16:19], s100 offen offset:0  lds
    v_mfma_f32_32x32x16_bf16 v[240:255], a[32:35], a[0:3], v[240:255]
    buffer_load_dwordx4 v12, s[16:19], s100 offen offset:1024  lds
    s_and_b32 s59, s59, 1023
    s_mul_i32 s68, s59, 1376
    s_waitcnt lgkmcnt(0)
    v_mfma_f32_32x32x16_bf16 v[128:143], a[36:39], a[40:43], v[128:143]
    s_waitcnt vmcnt(17)
    s_barrier
    s_add_u32 m0, s37, 0
    s_add_u32 s100, s34, s59
    buffer_load_dwordx4 v1, s[8:11], s100 offen offset:0  lds
    v_mfma_f32_32x32x16_bf16 v[144:159], a[36:39], a[44:47], v[144:159]
    ds_read_b128 a[0:3], v73
    ds_read_b128 a[4:7], v77 offset:16384
    ds_read_b128 a[8:11], v77 offset:20480
    v_mfma_f32_32x32x16_bf16 v[160:175], a[48:51], a[36:39], v[160:175]
    ds_read_b64_tr_b16 a[12:13], v81 offset:24576
    ds_read_b64_tr_b16 a[14:15], v81 offset:25344
    ds_read_b64_tr_b16 a[16:17], v81 offset:36864
    v_mfma_f32_32x32x16_bf16 v[176:191], a[52:55], a[36:39], v[176:191]
    ds_read_b64_tr_b16 a[18:19], v81 offset:37632
    ds_read_b64_tr_b16 a[20:21], v81 offset:24832
    ds_read_b64_tr_b16 a[22:23], v81 offset:25600
    v_mfma_f32_32x32x16_bf16 v[192:207], a[56:59], a[36:39], v[192:207]
    ds_read_b64_tr_b16 a[24:25], v81 offset:37120
    ds_read_b64_tr_b16 a[26:27], v81 offset:37888
    ds_read_b64_tr_b16 a[28:29], v81 offset:25088
    v_mfma_f32_32x32x16_bf16 v[208:223], a[60:63], a[36:39], v[208:223]
    ds_read_b64_tr_b16 a[30:31], v81 offset:25856
    ds_read_b64_tr_b16 a[32:33], v81 offset:37376
    ds_read_b64_tr_b16 a[34:35], v81 offset:38144
    v_mfma_f32_32x32x16_bf16 v[224:239], a[64:67], a[36:39], v[224:239]
    buffer_load_dwordx4 v2, s[8:11], s100 offen offset:1024  lds
    s_add_u32 s61, s3, 0
    buffer_load_dwordx4 v[96:99], v33, s[20:23], s61 offen sc1
    v_mfma_f32_32x32x16_bf16 v[240:255], a[68:71], a[36:39], v[240:255]
    buffer_load_dwordx4 v3, s[8:11], s100 offen offset:2048  lds
    s_add_u32 s61, s3, 4096
    buffer_load_dwordx4 v[100:103], v33, s[20:23], s61 offen sc1
    s_waitcnt lgkmcnt(0)
    v_mfma_f32_32x32x16_bf16 v[128:143], a[0:3], a[4:7], v[128:143]
    ds_read_b128 a[36:39], v74
    ds_read_b128 a[40:43], v78 offset:16384
    ds_read_b128 a[44:47], v78 offset:20480
    v_mfma_f32_32x32x16_bf16 v[144:159], a[0:3], a[8:11], v[144:159]
    ds_read_b64_tr_b16 a[48:49], v81 offset:27648
    ds_read_b64_tr_b16 a[50:51], v81 offset:28416
    ds_read_b64_tr_b16 a[52:53], v81 offset:39936
    v_mfma_f32_32x32x16_bf16 v[160:175], a[12:15], a[0:3], v[160:175]
    ds_read_b64_tr_b16 a[54:55], v81 offset:40704
    ds_read_b64_tr_b16 a[56:57], v81 offset:27904
    ds_read_b64_tr_b16 a[58:59], v81 offset:28672
    v_mfma_f32_32x32x16_bf16 v[176:191], a[16:19], a[0:3], v[176:191]
    ds_read_b64_tr_b16 a[60:61], v81 offset:40192
    ds_read_b64_tr_b16 a[62:63], v81 offset:40960
    ds_read_b64_tr_b16 a[64:65], v81 offset:28160
    v_mfma_f32_32x32x16_bf16 v[192:207], a[20:23], a[0:3], v[192:207]
    ds_read_b64_tr_b16 a[66:67], v81 offset:28928
    ds_read_b64_tr_b16 a[68:69], v81 offset:40448
    ds_read_b64_tr_b16 a[70:71], v81 offset:41216
    v_mfma_f32_32x32x16_bf16 v[208:223], a[24:27], a[0:3], v[208:223]
    buffer_load_dwordx4 v4, s[8:11], s100 offen offset:3072  lds
    s_add_u32 s61, s3, 8192
    buffer_load_dwordx4 v[104:107], v33, s[20:23], s61 offen sc1
    v_mfma_f32_32x32x16_bf16 v[224:239], a[28:31], a[0:3], v[224:239]
    s_add_u32 m0, s38, 0
    s_add_u32 s100, s35, s59
    buffer_load_dwordx4 v5, s[12:15], s100 offen offset:0  lds
    v_mfma_f32_32x32x16_bf16 v[240:255], a[32:35], a[0:3], v[240:255]
    buffer_load_dwordx4 v6, s[12:15], s100 offen offset:1024  lds
    s_add_u32 s61, s3, 12288
    buffer_load_dwordx4 v[108:111], v33, s[20:23], s61 offen sc1
    buffer_load_dwordx4 v[16:19], v25, s[20:23], 0 offen sc1
    s_waitcnt lgkmcnt(0)
    v_mfma_f32_32x32x16_bf16 v[128:143], a[36:39], a[40:43], v[128:143]
    ds_read_b128 a[0:3], v75
    ds_read_b128 a[4:7], v79 offset:16384
    ds_read_b128 a[8:11], v79 offset:20480
    v_mfma_f32_32x32x16_bf16 v[144:159], a[36:39], a[44:47], v[144:159]
    ds_read_b64_tr_b16 a[12:13], v81 offset:30720
    ds_read_b64_tr_b16 a[14:15], v81 offset:31488
    ds_read_b64_tr_b16 a[16:17], v81 offset:43008
    v_mfma_f32_32x32x16_bf16 v[160:175], a[48:51], a[36:39], v[160:175]
    ds_read_b64_tr_b16 a[18:19], v81 offset:43776
    ds_read_b64_tr_b16 a[20:21], v81 offset:30976
    ds_read_b64_tr_b16 a[22:23], v81 offset:31744
    v_mfma_f32_32x32x16_bf16 v[176:191], a[52:55], a[36:39], v[176:191]
    ds_read_b64_tr_b16 a[24:25], v81 offset:43264
    ds_read_b64_tr_b16 a[26:27], v81 offset:44032
    ds_read_b64_tr_b16 a[28:29], v81 offset:31232
    v_mfma_f32_32x32x16_bf16 v[192:207], a[56:59], a[36:39], v[192:207]
    ds_read_b64_tr_b16 a[30:31], v81 offset:32000
    ds_read_b64_tr_b16 a[32:33], v81 offset:43520
    ds_read_b64_tr_b16 a[34:35], v81 offset:44288
    v_mfma_f32_32x32x16_bf16 v[208:223], a[60:63], a[36:39], v[208:223]
    s_add_u32 m0, s39, 0
    s_add_u32 s100, s36, s68
    buffer_load_dwordx4 v7, s[16:19], s100 offen offset:0  lds
    v_mfma_f32_32x32x16_bf16 v[224:239], a[64:67], a[36:39], v[224:239]
    buffer_load_dwordx4 v8, s[16:19], s100 offen offset:1024  lds
    v_mfma_f32_32x32x16_bf16 v[240:255], a[68:71], a[36:39], v[240:255]
    buffer_load_dwordx4 v9, s[16:19], s100 offen offset:2048  lds
    s_waitcnt lgkmcnt(0)
    v_mfma_f32_32x32x16_bf16 v[128:143], a[0:3], a[4:7], v[128:143]
    ds_read_b128 a[36:39], v76
    ds_read_b128 a[40:43], v80 offset:16384
    ds_read_b128 a[44:47], v80 offset:20480
    v_mfma_f32_32x32x16_bf16 v[144:159], a[0:3], a[8:11], v[144:159]
    ds_read_b64_tr_b16 a[48:49], v81 offset:33792
    ds_read_b64_tr_b16 a[50:51], v81 offset:34560
    ds_read_b64_tr_b16 a[52:53], v81 offset:46080
    v_mfma_f32_32x32x16_bf16 v[160:175], a[12:15], a[0:3], v[160:175]
    ds_read_b64_tr_b16 a[54:55], v81 offset:46848
    ds_read_b64_tr_b16 a[56:57], v81 offset:34048
    ds_read_b64_tr_b16 a[58:59], v81 offset:34816
    v_mfma_f32_32x32x16_bf16 v[176:191], a[16:19], a[0:3], v[176:191]
    ds_read_b64_tr_b16 a[60:61], v81 offset:46336
    ds_read_b64_tr_b16 a[62:63], v81 offset:47104
    ds_read_b64_tr_b16 a[64:65], v81 offset:34304
    v_mfma_f32_32x32x16_bf16 v[192:207], a[20:23], a[0:3], v[192:207]
    ds_read_b64_tr_b16 a[66:67], v81 offset:35072
    ds_read_b64_tr_b16 a[68:69], v81 offset:46592
    ds_read_b64_tr_b16 a[70:71], v81 offset:47360
    v_mfma_f32_32x32x16_bf16 v[208:223], a[24:27], a[0:3], v[208:223]
    buffer_load_dwordx4 v10, s[16:19], s100 offen offset:3072  lds
    v_mfma_f32_32x32x16_bf16 v[224:239], a[28:31], a[0:3], v[224:239]
    s_add_u32 m0, s39, 4096
    s_add_u32 s59, s59, 128
    buffer_load_dwordx4 v11, s[16:19], s100 offen offset:0  lds
    v_mfma_f32_32x32x16_bf16 v[240:255], a[32:35], a[0:3], v[240:255]
    buffer_load_dwordx4 v12, s[16:19], s100 offen offset:1024  lds
    s_and_b32 s59, s59, 1023
    s_mul_i32 s68, s59, 1376
    s_waitcnt lgkmcnt(0)
    v_mfma_f32_32x32x16_bf16 v[128:143], a[36:39], a[40:43], v[128:143]
    s_waitcnt vmcnt(17)
    s_barrier
    s_add_u32 m0, s37, 49152
    s_add_u32 s100, s34, s59
    buffer_load_dwordx4 v1, s[8:11], s100 offen offset:0  lds
    v_mfma_f32_32x32x16_bf16 v[144:159], a[36:39], a[44:47], v[144:159]
    ds_read_b128 a[0:3], v82
    ds_read_b128 a[4:7], v86 offset:16384
    ds_read_b128 a[8:11], v86 offset:20480
    v_mfma_f32_32x32x16_bf16 v[160:175], a[48:51], a[36:39], v[160:175]
    ds_read_b64_tr_b16 a[12:13], v90 offset:24576
    ds_read_b64_tr_b16 a[14:15], v90 offset:25344
    ds_read_b64_tr_b16 a[16:17], v90 offset:36864
    v_mfma_f32_32x32x16_bf16 v[176:191], a[52:55], a[36:39], v[176:191]
    ds_read_b64_tr_b16 a[18:19], v90 offset:37632
    ds_read_b64_tr_b16 a[20:21], v90 offset:24832
    ds_read_b64_tr_b16 a[22:23], v90 offset:25600
    v_mfma_f32_32x32x16_bf16 v[192:207], a[56:59], a[36:39], v[192:207]
    ds_read_b64_tr_b16 a[24:25], v90 offset:37120
    ds_read_b64_tr_b16 a[26:27], v90 offset:37888
    ds_read_b64_tr_b16 a[28:29], v90 offset:25088
    v_mfma_f32_32x32x16_bf16 v[208:223], a[60:63], a[36:39], v[208:223]
    ds_read_b64_tr_b16 a[30:31], v90 offset:25856
    ds_read_b64_tr_b16 a[32:33], v90 offset:37376
    ds_read_b64_tr_b16 a[34:35], v90 offset:38144
    v_mfma_f32_32x32x16_bf16 v[224:239], a[64:67], a[36:39], v[224:239]
    buffer_load_dwordx4 v2, s[8:11], s100 offen offset:1024  lds
    v_mfma_f32_32x32x16_bf16 v[240:255], a[68:71], a[36:39], v[240:255]
    buffer_load_dwordx4 v3, s[8:11], s100 offen offset:2048  lds
    s_waitcnt lgkmcnt(0)
    v_mfma_f32_32x32x16_bf16 v[128:143], a[0:3], a[4:7], v[128:143]
    ds_read_b128 a[36:39], v83
    ds_read_b128 a[40:43], v87 offset:16384
    ds_read_b128 a[44:47], v87 offset:20480
    v_mfma_f32_32x32x16_bf16 v[144:159], a[0:3], a[8:11], v[144:159]
    ds_read_b64_tr_b16 a[48:49], v90 offset:27648
    ds_read_b64_tr_b16 a[50:51], v90 offset:28416
    ds_read_b64_tr_b16 a[52:53], v90 offset:39936
    s_waitcnt vmcnt(9)
    v_mfma_f32_32x32x16_bf16 v[160:175], a[12:15], a[0:3], v[160:175]
    ds_read_b64_tr_b16 a[54:55], v90 offset:40704
    ds_read_b64_tr_b16 a[56:57], v90 offset:27904
    ds_read_b64_tr_b16 a[58:59], v90 offset:28672
    v_min3_u32 v22, v98, v102, v19
    v_mfma_f32_32x32x16_bf16 v[176:191], a[16:19], a[0:3], v[176:191]
    ds_read_b64_tr_b16 a[60:61], v90 offset:40192
    ds_read_b64_tr_b16 a[62:63], v90 offset:40960
    ds_read_b64_tr_b16 a[64:65], v90 offset:28160
    v_max3_u32 v23, v98, v102, v19
    v_mfma_f32_32x32x16_bf16 v[192:207], a[20:23], a[0:3], v[192:207]
    ds_read_b64_tr_b16 a[66:67], v90 offset:28928
    ds_read_b64_tr_b16 a[68:69], v90 offset:40448
    ds_read_b64_tr_b16 a[70:71], v90 offset:41216
    v_min3_u32 v22, v106, v110, v22
    v_mfma_f32_32x32x16_bf16 v[208:223], a[24:27], a[0:3], v[208:223]
    buffer_load_dwordx4 v4, s[8:11], s100 offen offset:3072  lds
    v_max3_u32 v23, v106, v110, v23
    v_xor_b32 v22, s27, v22
    v_xor_b32 v23, s27, v23
    v_mfma_f32_32x32x16_bf16 v[224:239], a[28:31], a[0:3], v[224:239]
    s_add_u32 m0, s38, 49152
    s_add_u32 s100, s35, s59
    buffer_load_dwordx4 v5, s[12:15], s100 offen offset:0  lds
    v_or_b32 v22, v22, v23
    v_mfma_f32_32x32x16_bf16 v[240:255], a[32:35], a[0:3], v[240:255]
    buffer_load_dwordx4 v6, s[12:15], s100 offen offset:1024  lds
    v_cmp_ne_u32 vcc, 0, v22
    s_cbranch_vccnz L_cs_slow
L_cs_ok:
    v_add_f32 v96, v96, v100
    s_waitcnt lgkmcnt(0)
    v_mfma_f32_32x32x16_bf16 v[128:143], a[36:39], a[40:43], v[128:143]
    ds_read_b128 a[0:3], v84
    ds_read_b128 a[4:7], v88 offset:16384
    ds_read_b128 a[8:11], v88 offset:20480
    v_mfma_f32_32x32x16_bf16 v[144:159], a[36:39], a[44:47], v[144:159]
    ds_read_b64_tr_b16 a[12:13], v90 offset:30720
    ds_read_b64_tr_b16 a[14:15], v90 offset:31488
    ds_read_b64_tr_b16 a[16:17], v90 offset:43008
    v_add_f32 v97, v97, v101
    v_mfma_f32_32x32x16_bf16 v[160:175], a[48:51], a[36:39], v[160:175]
    ds_read_b64_tr_b16 a[18:19], v90 offset:43776
    ds_read_b64_tr_b16 a[20:21], v90 offset:30976
    ds_read_b64_tr_b16 a[22:23], v90 offset:31744
    v_add_f32 v104, v104, v108
    v_mfma_f32_32x32x16_bf16 v[176:191], a[52:55], a[36:39], v[176:191]
    ds_read_b64_tr_b16 a[24:25], v90 offset:43264
    ds_read_b64_tr_b16 a[26:27], v90 offset:44032
    ds_read_b64_tr_b16 a[28:29], v90 offset:31232
    v_add_f32 v105, v105, v109
    v_mfma_f32_32x32x16_bf16 v[192:207], a[56:59], a[36:39], v[192:207]
    ds_read_b64_tr_b16 a[30:31], v90 offset:32000
    ds_read_b64_tr_b16 a[32:33], v90 offset:43520
    ds_read_b64_tr_b16 a[34:35], v90 offset:44288
    v_mov_b32 v30, v16
    v_mfma_f32_32x32x16_bf16 v[208:223], a[60:63], a[36:39], v[208:223]
    s_add_u32 m0, s39, 49152
    s_add_u32 s100, s36, s68
    buffer_load_dwordx4 v7, s[16:19], s100 offen offset:0  lds
    v_mov_b32 v31, v17
    v_mfma_f32_32x32x16_bf16 v[224:239], a[64:67], a[36:39], v[224:239]
    buffer_load_dwordx4 v8, s[16:19], s100 offen offset:1024  lds
    v_mov_b32 v19, v18
    v_add_f32 v96, v96, v104
    v_add_f32 v98, v97, v105
    v_mfma_f32_32x32x16_bf16 v[240:255], a[68:71], a[36:39], v[240:255]
    buffer_load_dwordx4 v9, s[16:19], s100 offen offset:2048  lds
    v_mov_b32 v97, v96
    v_mov_b32 v99, v98
    v_permlane32_swap_b32 v16, v30
    s_waitcnt lgkmcnt(0)
    v_mfma_f32_32x32x16_bf16 v[128:143], a[0:3], a[4:7], v[128:143]
    ds_read_b128 a[36:39], v85
    ds_read_b128 a[40:43], v89 offset:16384
    ds_read_b128 a[44:47], v89 offset:20480
    v_mfma_f32_32x32x16_bf16 v[144:159], a[0:3], a[8:11], v[144:159]
    ds_read_b64_tr_b16 a[48:49], v90 offset:33792
    ds_read_b64_tr_b16 a[50:51], v90 offset:34560
    ds_read_b64_tr_b16 a[52:53], v90 offset:46080
    v_permlane32_swap_b32 v17, v31
    v_mfma_f32_32x32x16_bf16 v[160:175], a[12:15], a[0:3], v[160:175]
    ds_read_b64_tr_b16 a[54:55], v90 offset:46848
    ds_read_b64_tr_b16 a[56:57], v90 offset:34048
    ds_read_b64_tr_b16 a[58:59], v90 offset:34816
    v_permlane32_swap_b32 v18, v19
    v_mfma_f32_32x32x16_bf16 v[176:191], a[16:19], a[0:3], v[176:191]
    ds_read_b64_tr_b16 a[60:61], v90 offset:46336
    ds_read_b64_tr_b16 a[62:63], v90 offset:47104
    ds_read_b64_tr_b16 a[64:65], v90 offset:34304
    v_permlane32_swap_b32 v96, v97
    v_mfma_f32_32x32x16_bf16 v[192:207], a[20:23], a[0:3], v[192:207]
    ds_read_b64_tr_b16 a[66:67], v90 offset:35072
    ds_read_b64_tr_b16 a[68:69], v90 offset:46592
    ds_read_b64_tr_b16 a[70:71], v90 offset:47360
    v_permlane32_swap_b32 v98, v99
    v_mfma_f32_32x32x16_bf16 v[208:223], a[24:27], a[0:3], v[208:223]
    buffer_load_dwordx4 v10, s[16:19], s100 offen offset:3072  lds
    v_cvt_pk_bf16_f32 v92, -v16, -v16
    v_cmp_gt_u32 vcc, 32, v0
    v_add_f32 v96, v96, v97
    v_mfma_f32_32x32x16_bf16 v[224:239], a[28:31], a[0:3], v[224:239]
    s_add_u32 m0, s39, 53248
    s_add_u32 s59, s59, 128
    buffer_load_dwordx4 v11, s[16:19], s100 offen offset:0  lds
    v_add_f32 v98, v98, v99
    v_mfma_f32_32x32x16_bf16 v[240:255], a[32:35], a[0:3], v[240:255]
    buffer_load_dwordx4 v12, s[16:19], s100 offen offset:1024  lds
    s_and_b32 s59, s59, 1023
    s_mul_i32 s68, s59, 1376
    v_cndmask_b32 v92, v93, v92, vcc
    s_waitcnt lgkmcnt(0)
    v_mfma_f32_32x32x16_bf16 v[128:143], a[36:39], a[40:43], v[128:143]
    s_waitcnt vmcnt(12)
    s_barrier
    v_readlane_b32 s40, v14, 32
    v_readlane_b32 s41, v14, 33
    s_add_u32 m0, s96, 151552
    s_nop 2
    v_readlane_b32 s42, v14, 34
    buffer_load_dwordx4 v13, s[72:75], s40 offen  lds
    v_mfma_f32_32x32x16_bf16 v[144:159], a[36:39], a[44:47], v[144:159]
    ds_read_b128 a[0:3], v64
    ds_read_b128 a[4:7], v68 offset:16384
    ds_read_b128 a[8:11], v68 offset:20480
    v_mov_b32 v16, v17
    v_mfma_f32_32x32x16_bf16 v[160:175], a[48:51], a[36:39], v[160:175]
    ds_read_b64_tr_b16 a[12:13], v72 offset:24576
    ds_read_b64_tr_b16 a[14:15], v72 offset:25344
    ds_read_b64_tr_b16 a[16:17], v72 offset:36864
    v_cvt_pk_bf16_f32 v22, v96, v98
    v_mfma_f32_32x32x16_bf16 v[176:191], a[52:55], a[36:39], v[176:191]
    ds_read_b64_tr_b16 a[18:19], v72 offset:37632
    ds_read_b64_tr_b16 a[20:21], v72 offset:24832
    ds_read_b64_tr_b16 a[22:23], v72 offset:25600
    v_lshlrev_b32 v97, 16, v22
    v_mfma_f32_32x32x16_bf16 v[192:207], a[56:59], a[36:39], v[192:207]
    ds_read_b64_tr_b16 a[24:25], v72 offset:37120
    ds_read_b64_tr_b16 a[26:27], v72 offset:37888
    ds_read_b64_tr_b16 a[28:29], v72 offset:25088
    v_and_b32 v99, 0xffff0000, v22
    v_mfma_f32_32x32x16_bf16 v[208:223], a[60:63], a[36:39], v[208:223]
    ds_read_b64_tr_b16 a[30:31], v72 offset:25856
    ds_read_b64_tr_b16 a[32:33], v72 offset:37376
    ds_read_b64_tr_b16 a[34:35], v72 offset:38144
    v_sub_f32 v96, v96, v97
    v_mfma_f32_32x32x16_bf16 v[224:239], a[64:67], a[36:39], v[224:239]
    s_add_u32 m0, s96, 155648
    v_readlane_b32 s43, v14, 0
    buffer_load_dwordx4 v13, s[76:79], s41 offen  lds
    v_sub_f32 v98, v98, v99
    v_mfma_f32_32x32x16_bf16 v[240:255], a[68:71], a[36:39], v[240:255]
    s_add_u32 m0, s96, 159744
    v_readlane_b32 s40, v14, 1
    buffer_load_dwordx4 v13, s[72:75], s42 offen  lds
    v_cvt_pk_bf16_f32 v22, v97, v96
    s_waitcnt lgkmcnt(0)
    v_mfma_f32_32x32x16_bf16 v[128:143], a[0:3], a[4:7], v[128:143]
    ds_read_b128 a[36:39], v65
    ds_read_b128 a[40:43], v69 offset:16384
    ds_read_b128 a[44:47], v69 offset:20480
    v_mfma_f32_32x32x16_bf16 v[144:159], a[0:3], a[8:11], v[144:159]
    ds_read_b64_tr_b16 a[48:49], v72 offset:27648
    ds_read_b64_tr_b16 a[50:51], v72 offset:28416
    ds_read_b64_tr_b16 a[52:53], v72 offset:39936
    v_cvt_pk_bf16_f32 v23, v99, v98
    v_mfma_f32_32x32x16_bf16 v[160:175], a[12:15], a[0:3], v[160:175]
    ds_read_b64_tr_b16 a[54:55], v72 offset:40704
    ds_read_b64_tr_b16 a[56:57], v72 offset:27904
    ds_read_b64_tr_b16 a[58:59], v72 offset:28672
    ds_write2_b32 v32, v22, v23 offset0:0 offset1:32
    v_mfma_f32_32x32x16_bf16 v[176:191], a[16:19], a[0:3], v[176:191]
    ds_read_b64_tr_b16 a[60:61], v72 offset:40192
    ds_read_b64_tr_b16 a[62:63], v72 offset:40960
    ds_read_b64_tr_b16 a[64:65], v72 offset:28160
    ds_write_b32 v37, v17
    v_mfma_f32_32x32x16_bf16 v[192:207], a[20:23], a[0:3], v[192:207]
    ds_read_b64_tr_b16 a[66:67], v72 offset:28928
    ds_read_b64_tr_b16 a[68:69], v72 offset:40448
    ds_read_b64_tr_b16 a[70:71], v72 offset:41216
    v_mfma_f32_32x32x16_bf16 v[208:223], a[24:27], a[0:3], v[208:223]
    s_add_u32 m0, s96, 98304
    v_readlane_b32 s41, v14, 2
    buffer_load_dwordx4 v13, s[72:75], s43 offen  lds
    v_mfma_f32_32x32x16_bf16 v[224:239], a[28:31], a[0:3], v[224:239]
    s_add_u32 m0, s96, 102400
    v_readlane_b32 s42, v14, 3
    buffer_load_dwordx4 v13, s[76:79], s40 offen  lds
    v_mfma_f32_32x32x16_bf16 v[240:255], a[32:35], a[0:3], v[240:255]
    s_add_u32 m0, s96, 106496
    v_readlane_b32 s43, v14, 4
    buffer_load_dwordx4 v13, s[72:75], s41 offen  lds
    s_waitcnt lgkmcnt(0)
    v_mfma_f32_32x32x16_bf16 v[128:143], a[36:39], a[40:43], v[128:143]
    ds_read_b128 a[0:3], v66
    ds_read_b128 a[4:7], v70 offset:16384
    ds_read_b128 a[8:11], v70 offset:20480
    v_mfma_f32_32x32x16_bf16 v[144:159], a[36:39], a[44:47], v[144:159]
    ds_read_b64_tr_b16 a[12:13], v72 offset:30720
    ds_read_b64_tr_b16 a[14:15], v72 offset:31488
    ds_read_b64_tr_b16 a[16:17], v72 offset:43008
    v_mfma_f32_32x32x16_bf16 v[160:175], a[48:51], a[36:39], v[160:175]
    ds_read_b64_tr_b16 a[18:19], v72 offset:43776
    ds_read_b64_tr_b16 a[20:21], v72 offset:30976
    ds_read_b64_tr_b16 a[22:23], v72 offset:31744
    v_mfma_f32_32x32x16_bf16 v[176:191], a[52:55], a[36:39], v[176:191]
    ds_read_b64_tr_b16 a[24:25], v72 offset:43264
    ds_read_b64_tr_b16 a[26:27], v72 offset:44032
    ds_read_b64_tr_b16 a[28:29], v72 offset:31232
    v_mfma_f32_32x32x16_bf16 v[192:207], a[56:59], a[36:39], v[192:207]
    ds_read_b64_tr_b16 a[30:31], v72 offset:32000
    ds_read_b64_tr_b16 a[32:33], v72 offset:43520
    ds_read_b64_tr_b16 a[34:35], v72 offset:44288
    v_mfma_f32_32x32x16_bf16 v[208:223], a[60:63], a[36:39], v[208:223]
    s_add_u32 m0, s96, 110592
    v_readlane_b32 s40, v14, 5
    buffer_load_dwordx4 v13, s[76:79], s42 offen  lds
    v_mfma_f32_32x32x16_bf16 v[224:239], a[64:67], a[36:39], v[224:239]
    s_add_u32 m0, s96, 114688
    v_readlane_b32 s41, v14, 6
    buffer_load_dwordx4 v13, s[72:75], s43 offen  lds
    v_mfma_f32_32x32x16_bf16 v[240:255], a[68:71], a[36:39], v[240:255]
    s_add_u32 m0, s96, 118784
    v_readlane_b32 s42, v14, 7
    buffer_load_dwordx4 v13, s[76:79], s40 offen  lds
    s_waitcnt lgkmcnt(0)
    v_mfma_f32_32x32x16_bf16 v[128:143], a[0:3], a[4:7], v[128:143]
    ds_read_b128 a[36:39], v67
    ds_read_b128 a[40:43], v71 offset:16384
    ds_read_b128 a[44:47], v71 offset:20480
    v_mfma_f32_32x32x16_bf16 v[144:159], a[0:3], a[8:11], v[144:159]
    ds_read_b64_tr_b16 a[48:49], v72 offset:33792
    ds_read_b64_tr_b16 a[50:51], v72 offset:34560
    ds_read_b64_tr_b16 a[52:53], v72 offset:46080
    v_mfma_f32_32x32x16_bf16 v[160:175], a[12:15], a[0:3], v[160:175]
    ds_read_b64_tr_b16 a[54:55], v72 offset:46848
    ds_read_b64_tr_b16 a[56:57], v72 offset:34048
    ds_read_b64_tr_b16 a[58:59], v72 offset:34816
    v_mfma_f32_32x32x16_bf16 v[176:191], a[16:19], a[0:3], v[176:191]
    ds_read_b64_tr_b16 a[60:61], v72 offset:46336
    ds_read_b64_tr_b16 a[62:63], v72 offset:47104
    ds_read_b64_tr_b16 a[64:65], v72 offset:34304
    v_mfma_f32_32x32x16_bf16 v[192:207], a[20:23], a[0:3], v[192:207]
    ds_read_b64_tr_b16 a[66:67], v72 offset:35072
    ds_read_b64_tr_b16 a[68:69], v72 offset:46592
    ds_read_b64_tr_b16 a[70:71], v72 offset:47360
    v_mfma_f32_32x32x16_bf16 v[208:223], a[24:27], a[0:3], v[208:223]
    s_add_u32 m0, s96, 122880
    v_readlane_b32 s43, v14, 8
    buffer_load_dwordx4 v13, s[72:75], s41 offen  lds
    v_mfma_f32_32x32x16_bf16 v[224:239], a[28:31], a[0:3], v[224:239]
    s_add_u32 m0, s96, 126976
    v_readlane_b32 s40, v14, 9
    buffer_load_dwordx4 v13, s[76:79], s42 offen  lds
    v_mfma_f32_32x32x16_bf16 v[240:255], a[32:35], a[0:3], v[240:255]
    s_add_u32 m0, s96, 131072
    v_readlane_b32 s41, v14, 10
    buffer_load_dwordx4 v13, s[72:75], s43 offen  lds
    s_waitcnt lgkmcnt(0)
    v_mfma_f32_32x32x16_bf16 v[128:143], a[36:39], a[40:43], v[128:143]
    s_waitcnt vmcnt(12)
    s_barrier
    v_mfma_f32_32x32x16_bf16 v[144:159], a[36:39], a[44:47], v[144:159]
    ds_read_b128 a[124:127], v73
    ds_read_b128 a[140:143], v77 offset:16384
    ds_read_b128 a[144:147], v77 offset:20480
    v_mfma_f32_32x32x16_bf16 v[160:175], a[48:51], a[36:39], v[160:175]
    ds_read_b128 a[128:131], v74
    ds_read_b128 a[148:151], v78 offset:16384
    ds_read_b128 a[152:155], v78 offset:20480
    v_mfma_f32_32x32x16_bf16 v[176:191], a[52:55], a[36:39], v[176:191]
    ds_read_b128 a[132:135], v75
    ds_read_b128 a[156:159], v79 offset:16384
    ds_read_b128 a[160:163], v79 offset:20480
    v_mfma_f32_32x32x16_bf16 v[192:207], a[56:59], a[36:39], v[192:207]
    ds_read_b128 a[136:139], v76
    ds_read_b128 a[164:167], v80 offset:16384
    v_mfma_f32_32x32x16_bf16 v[208:223], a[60:63], a[36:39], v[208:223]
    ds_read_b128 a[168:171], v80 offset:20480
    v_mfma_f32_32x32x16_bf16 v[224:239], a[64:67], a[36:39], v[224:239]
    s_add_u32 m0, s96, 135168
    v_readlane_b32 s42, v14, 11
    buffer_load_dwordx4 v13, s[76:79], s40 offen  lds
    v_mfma_f32_32x32x16_bf16 v[240:255], a[68:71], a[36:39], v[240:255]
    s_add_u32 m0, s96, 139264
    v_readlane_b32 s43, v14, 12
    buffer_load_dwordx4 v13, s[72:75], s41 offen  lds
    s_waitcnt lgkmcnt(7)
    v_mfma_f32_32x32x16_bf16 v[128:143], a[124:127], a[140:143], v[128:143]
    ds_read_b32 a72, v28 offset:0
    ds_read_b32 a74, v28 offset:128
    v_mfma_f32_32x32x16_bf16 v[144:159], a[124:127], a[144:147], v[144:159]
    ds_read_b128 v[96:99], v29 offset:0
    ds_read_b128 v[100:103], v29 offset:16
    s_add_u32 m0, s96, 143360
    v_readlane_b32 s40, v14, 13
    buffer_load_dwordx4 v13, s[76:79], s42 offen  lds
    v_mfma_f32_32x32x16_bf16 v[128:143], a[128:131], a[148:151], v[128:143]
    ds_read_b128 v[104:107], v29 offset:32
    ds_read_b128 v[108:111], v29 offset:48
    s_waitcnt lgkmcnt(9)
    v_mfma_f32_32x32x16_bf16 v[144:159], a[128:131], a[152:155], v[144:159]
    ds_read_b32 a76, v28 offset:256
    ds_read_b32 a78, v28 offset:384
    v_mfma_f32_32x32x16_bf16 v[128:143], a[132:135], a[156:159], v[128:143]
    ds_read_b32 a80, v28 offset:512
    ds_read_b32 a82, v28 offset:640
    s_add_u32 m0, s96, 0
    v_readlane_b32 s41, v14, 14
    buffer_load_dwordx4 v13, s[72:75], s43 offen  lds
    v_mfma_f32_32x32x16_bf16 v[144:159], a[132:135], a[160:163], v[144:159]
    ds_read_b32 a84, v28 offset:768
    ds_read_b32 a86, v28 offset:896
    s_waitcnt lgkmcnt(6)
    v_mfma_f32_32x32x16_bf16 v[128:143], a[136:139], a[164:167], v[128:143]
    ds_read_b64_tr_b16 a[12:13], v81 offset:24576
    ds_read_b64_tr_b16 a[14:15], v81 offset:25344
    v_mfma_f32_32x32x16_bf16 v[144:159], a[136:139], a[168:171], v[144:159]
    ds_read_b64_tr_b16 a[16:17], v81 offset:36864
    ds_read_b64_tr_b16 a[18:19], v81 offset:37632
    s_add_u32 m0, s96, 4096
    v_readlane_b32 s42, v14, 15
    buffer_load_dwordx4 v13, s[76:79], s40 offen  lds
    v_mfma_f32_32x32x16_bf16 v[128:143], v[92:95], a[72:75], v[128:143]
    ds_read_b64_tr_b16 a[20:21], v81 offset:24832
    ds_read_b64_tr_b16 a[22:23], v81 offset:25600
    s_waitcnt lgkmcnt(2)
    v_mfma_f32_32x32x16_bf16 v[144:159], v[92:95], a[74:77], v[144:159]
    ds_read_b64_tr_b16 a[24:25], v81 offset:37120
    ds_read_b64_tr_b16 a[26:27], v81 offset:37888
    v_mfma_f32_32x32x16_bf16 v[160:175], a[12:15], a[124:127], v[160:175]
    ds_read_b64_tr_b16 a[28:29], v81 offset:25088
    ds_read_b64_tr_b16 a[30:31], v81 offset:25856
    s_add_u32 m0, s96, 8192
    v_readlane_b32 s43, v14, 16
    buffer_load_dwordx4 v13, s[72:75], s41 offen  lds
    v_mfma_f32_32x32x16_bf16 v[176:191], a[16:19], a[124:127], v[176:191]
    ds_read_b64_tr_b16 a[32:33], v81 offset:37376
    ds_read_b64_tr_b16 a[34:35], v81 offset:38144
    s_waitcnt lgkmcnt(2)
    v_mfma_f32_32x32x16_bf16 v[192:207], a[20:23], a[124:127], v[192:207]
    ds_read_b64_tr_b16 a[48:49], v81 offset:27648
    ds_read_b64_tr_b16 a[50:51], v81 offset:28416
    v_mfma_f32_32x32x16_bf16 v[208:223], a[24:27], a[124:127], v[208:223]
    ds_read_b64_tr_b16 a[52:53], v81 offset:39936
    ds_read_b64_tr_b16 a[54:55], v81 offset:40704
    s_add_u32 m0, s96, 12288
    v_readlane_b32 s40, v14, 17
    buffer_load_dwordx4 v13, s[76:79], s42 offen  lds
    v_mul_f32 v128, v128, v96
    v_mfma_f32_32x32x16_bf16 v[224:239], a[28:31], a[124:127], v[224:239]
    ds_read_b64_tr_b16 a[56:57], v81 offset:27904
    ds_read_b64_tr_b16 a[58:59], v81 offset:28672
    v_mul_f32 v144, v144, v96
    v_mul_f32 v129, v129, v97
    v_mul_f32 v145, v145, v97
    v_fma_f32 v54, v44, v128, v129
    s_waitcnt lgkmcnt(2)
    v_mfma_f32_32x32x16_bf16 v[240:255], a[32:35], a[124:127], v[240:255]
    ds_read_b64_tr_b16 a[60:61], v81 offset:40192
    ds_read_b64_tr_b16 a[62:63], v81 offset:40960
    v_fma_f32 v55, v44, v144, v145
    v_fma_f32 v54, -v45, v144, v54
    v_fma_f32 v55, v45, v128, v55
    v_mfma_f32_32x32x16_bf16 v[160:175], a[48:51], a[128:131], v[160:175]
    ds_read_b64_tr_b16 a[64:65], v81 offset:28160
    ds_read_b64_tr_b16 a[66:67], v81 offset:28928
    s_add_u32 m0, s96, 16384
    v_readlane_b32 s41, v14, 18
    buffer_load_dwordx4 v13, s[72:75], s43 offen  lds
    v_mul_f32 v130, v130, v98
    v_mfma_f32_32x32x16_bf16 v[176:191], a[52:55], a[128:131], v[176:191]
    ds_read_b64_tr_b16 a[68:69], v81 offset:40448
    ds_read_b64_tr_b16 a[70:71], v81 offset:41216
    v_mul_f32 v146, v146, v98
    v_fma_f32 v52, v44, v54, v130
    v_fma_f32 v53, v44, v55, v146
    v_fma_f32 v52, -v45, v55, v52
    s_waitcnt lgkmcnt(2)
    v_mfma_f32_32x32x16_bf16 v[192:207], a[56:59], a[128:131], v[192:207]
    ds_read_b64_tr_b16 a[12:13], v81 offset:30720
    ds_read_b64_tr_b16 a[14:15], v81 offset:31488
    v_fma_f32 v53, v45, v54, v53
    v_mul_f32 v131, v131, v99
    v_mul_f32 v147, v147, v99
    v_mfma_f32_32x32x16_bf16 v[208:223], a[60:63], a[128:131], v[208:223]
    ds_read_b64_tr_b16 a[16:17], v81 offset:43008
    ds_read_b64_tr_b16 a[18:19], v81 offset:43776
    s_add_u32 m0, s96, 20480
    v_readlane_b32 s42, v14, 19
    buffer_load_dwordx4 v13, s[76:79], s40 offen  lds
    v_fma_f32 v54, v44, v52, v131
    v_mfma_f32_32x32x16_bf16 v[224:239], a[64:67], a[128:131], v[224:239]
    ds_read_b64_tr_b16 a[20:21], v81 offset:30976
    ds_read_b64_tr_b16 a[22:23], v81 offset:31744
    v_fma_f32 v55, v44, v53, v147
    v_fma_f32 v54, -v45, v53, v54
    v_fma_f32 v55, v45, v52, v55
    v_mul_f32 v132, v132, v100
    s_waitcnt lgkmcnt(2)
    v_mfma_f32_32x32x16_bf16 v[240:255], a[68:71], a[128:131], v[240:255]
    ds_read_b64_tr_b16 a[24:25], v81 offset:43264
    ds_read_b64_tr_b16 a[26:27], v81 offset:44032
    v_mul_f32 v148, v148, v100
    v_fma_f32 v52, v44, v54, v132
    v_fma_f32 v53, v44, v55, v148
    v_mfma_f32_32x32x16_bf16 v[160:175], a[12:15], a[132:135], v[160:175]
    ds_read_b64_tr_b16 a[28:29], v81 offset:31232
    ds_read_b64_tr_b16 a[30:31], v81 offset:32000
    s_add_u32 m0, s96, 24576
    v_readlane_b32 s43, v14, 20
    buffer_load_dwordx4 v13, s[72:75], s41 offen  lds
    v_fma_f32 v52, -v45, v55, v52
    v_mfma_f32_32x32x16_bf16 v[176:191], a[16:19], a[132:135], v[176:191]
    ds_read_b64_tr_b16 a[32:33], v81 offset:43520
    ds_read_b64_tr_b16 a[34:35], v81 offset:44288
    v_fma_f32 v53, v45, v54, v53
    v_mul_f32 v133, v133, v101
    v_mul_f32 v149, v149, v101
    v_fma_f32 v54, v44, v52, v133
    s_waitcnt lgkmcnt(2)
    v_mfma_f32_32x32x16_bf16 v[192:207], a[20:23], a[132:135], v[192:207]
    ds_read_b64_tr_b16 a[48:49], v81 offset:33792
    ds_read_b64_tr_b16 a[50:51], v81 offset:34560
    v_fma_f32 v55, v44, v53, v149
    v_fma_f32 v54, -v45, v53, v54
    v_fma_f32 v55, v45, v52, v55
    v_mfma_f32_32x32x16_bf16 v[208:223], a[24:27], a[132:135], v[208:223]
    ds_read_b64_tr_b16 a[52:53], v81 offset:46080
    ds_read_b64_tr_b16 a[54:55], v81 offset:46848
    s_add_u32 m0, s96, 28672
    v_readlane_b32 s40, v14, 21
    buffer_load_dwordx4 v13, s[76:79], s42 offen  lds
    v_mul_f32 v134, v134, v102
    v_mfma_f32_32x32x16_bf16 v[224:239], a[28:31], a[132:135], v[224:239]
    ds_read_b64_tr_b16 a[56:57], v81 offset:34048
    ds_read_b64_tr_b16 a[58:59], v81 offset:34816
    v_mul_f32 v150, v150, v102
    v_fma_f32 v52, v44, v54, v134
    v_fma_f32 v53, v44, v55, v150
    v_fma_f32 v52, -v45, v55, v52
    s_waitcnt lgkmcnt(2)
    v_mfma_f32_32x32x16_bf16 v[240:255], a[32:35], a[132:135], v[240:255]
    ds_read_b64_tr_b16 a[60:61], v81 offset:46336
    ds_read_b64_tr_b16 a[62:63], v81 offset:47104
    v_fma_f32 v53, v45, v54, v53
    v_mul_f32 v135, v135, v103
    v_mul_f32 v151, v151, v103
    v_mfma_f32_32x32x16_bf16 v[160:175], a[48:51], a[136:139], v[160:175]
    ds_read_b64_tr_b16 a[64:65], v81 offset:34304
    ds_read_b64_tr_b16 a[66:67], v81 offset:35072
    s_add_u32 m0, s96, 32768
    v_readlane_b32 s41, v14, 22
    buffer_load_dwordx4 v13, s[72:75], s43 offen  lds
    v_fma_f32 v54, v44, v52, v135
    v_mfma_f32_32x32x16_bf16 v[176:191], a[52:55], a[136:139], v[176:191]
    ds_read_b64_tr_b16 a[68:69], v81 offset:46592
    ds_read_b64_tr_b16 a[70:71], v81 offset:47360
    v_fma_f32 v55, v44, v53, v151
    v_fma_f32 v54, -v45, v53, v54
    v_fma_f32 v55, v45, v52, v55
    v_mul_f32 v136, v136, v104
    s_waitcnt lgkmcnt(2)
    v_mfma_f32_32x32x16_bf16 v[192:207], a[56:59], a[136:139], v[192:207]
    s_add_u32 m0, s96, 36864
    v_readlane_b32 s42, v14, 23
    buffer_load_dwordx4 v13, s[76:79], s40 offen  lds
    v_mul_f32 v152, v152, v104
    v_fma_f32 v52, v44, v54, v136
    v_mfma_f32_32x32x16_bf16 v[208:223], a[60:63], a[136:139], v[208:223]
    v_fma_f32 v53, v44, v55, v152
    v_fma_f32 v52, -v45, v55, v52
    v_fma_f32 v53, v45, v54, v53
    v_mul_f32 v137, v137, v105
    v_mul_f32 v153, v153, v105
    v_fma_f32 v54, v44, v52, v137
    v_mfma_f32_32x32x16_bf16 v[224:239], a[64:67], a[136:139], v[224:239]
    v_fma_f32 v55, v44, v53, v153
    v_fma_f32 v54, -v45, v53, v54
    v_fma_f32 v55, v45, v52, v55
    v_mul_f32 v138, v138, v106
    v_mul_f32 v154, v154, v106
    v_fma_f32 v52, v44, v54, v138
    s_waitcnt lgkmcnt(0)
    v_mfma_f32_32x32x16_bf16 v[240:255], a[68:71], a[136:139], v[240:255]
    s_add_u32 m0, s96, 40960
    s_nop 0
    buffer_load_dwordx4 v13, s[72:75], s41 offen  lds
    v_fma_f32 v53, v44, v55, v154
    v_fma_f32 v52, -v45, v55, v52
    v_mfma_f32_32x32x16_bf16 v[160:175], a[76:79], v[92:95], v[160:175]
    v_fma_f32 v53, v45, v54, v53
    v_mul_f32 v139, v139, v107
    v_mul_f32 v155, v155, v107
    v_fma_f32 v54, v44, v52, v139
    v_fma_f32 v55, v44, v53, v155
    v_fma_f32 v54, -v45, v53, v54
    v_mfma_f32_32x32x16_bf16 v[176:191], a[78:81], v[92:95], v[176:191]
    v_fma_f32 v55, v45, v52, v55
    v_mul_f32 v140, v140, v108
    v_mul_f32 v156, v156, v108
    v_fma_f32 v52, v44, v54, v140
    v_fma_f32 v53, v44, v55, v156
    v_fma_f32 v52, -v45, v55, v52
    v_mfma_f32_32x32x16_bf16 v[192:207], a[80:83], v[92:95], v[192:207]
    s_add_u32 m0, s96, 45056
    s_nop 0
    buffer_load_dwordx4 v13, s[76:79], s42 offen  lds
    v_fma_f32 v53, v45, v54, v53
    v_mul_f32 v141, v141, v109
    v_mul_f32 v157, v157, v109
    v_mfma_f32_32x32x16_bf16 v[208:223], a[82:85], v[92:95], v[208:223]
    v_fma_f32 v54, v44, v52, v141
    v_fma_f32 v55, v44, v53, v157
    v_fma_f32 v54, -v45, v53, v54
    v_fma_f32 v55, v45, v52, v55
    v_mul_f32 v142, v142, v110
    v_mul_f32 v158, v158, v110
    v_mfma_f32_32x32x16_bf16 v[224:239], a[84:87], v[92:95], v[224:239]
    v_fma_f32 v52, v44, v54, v142
    v_fma_f32 v53, v44, v55, v158
    v_fma_f32 v52, -v45, v55, v52
    v_fma_f32 v53, v45, v54, v53
    v_mul_f32 v143, v143, v111
    v_mul_f32 v159, v159, v111
    v_mfma_f32_32x32x16_bf16 v[240:255], a[86:89], v[92:95], v[240:255]
    v_fma_f32 v54, v44, v52, v143
    v_fma_f32 v55, v44, v53, v159
    v_fma_f32 v54, -v45, v53, v54
    v_fma_f32 v55, v45, v52, v55
    v_and_b32 v22, 31, v0
    v_lshrrev_b32 v23, 5, v0
    v_lshlrev_b32 v24, 3, v22
    v_add_u32 v24, 148480, v24
    v_lshl_add_u32 v25, v23, 8, v24
    s_lshl_b32 s33, s26, 9
    v_add_u32 v25, s33, v25
    ds_write_b64 v25, v[54:55]
    v_mov_b32 v60, 0xc0135761
    v_mov_b32 v61, 0xc0135761
    v_mov_b32 v62, 0xbdd2d3e8
    v_mov_b32 v63, 0xbdd2d3e8
    s_waitcnt lgkmcnt(0)
    s_barrier
    ds_read_b64 v[100:101], v24 offset:0
    ds_read_b64 v[102:103], v24 offset:256
    ds_read_b64 v[104:105], v24 offset:512
    ds_read_b64 v[106:107], v24 offset:768
    ds_read_b64 v[108:109], v24 offset:1024
    ds_read_b64 v[110:111], v24 offset:1280
    ds_read_b64 v[112:113], v24 offset:1536
    ds_read_b64 v[114:115], v24 offset:1792
    s_lshl_b32 s33, s24, 2
    s_add_u32 s97, s33, s26
    s_mul_i32 s45, s97, 153600
    s_add_u32 s45, s45, 4194304
    s_lshl_b32 s33, s28, 11
    s_add_u32 s3, s33, s45
    s_lshl_b32 s33, s25, 13
    s_add_u32 s33, s33, 14680064
    s_add_u32 s4, s70, s33
    s_addc_u32 s5, s71, 0
    s_mov_b32 s6, 8192
    s_lshl_b32 s47, s24, 9
    s_cmp_lg_u32 s26, 0
    s_cbranch_scc1 L_nopub
    v_mov_b32 v98, s27
    v_mov_b32 v99, s27
    v_lshlrev_b32 v26, 4, v22
    s_waitcnt lgkmcnt(0)
    v_fma_f32 v96, v46, v100, v102
    v_fma_f32 v97, v46, v101, v103
    v_fma_f32 v96, -v47, v101, v96
    v_fma_f32 v97, v47, v100, v97
    v_fma_f32 v52, v46, v96, v104
    v_fma_f32 v53, v46, v97, v105
    v_fma_f32 v52, -v47, v97, v52
    v_fma_f32 v53, v47, v96, v53
    v_fma_f32 v96, v46, v52, v106
    v_fma_f32 v97, v46, v53, v107
    v_fma_f32 v96, -v47, v53, v96
    v_fma_f32 v97, v47, v52, v97
    v_fma_f32 v52, v46, v96, v108
    v_fma_f32 v53, v46, v97, v109
    v_fma_f32 v52, -v47, v97, v52
    v_fma_f32 v53, v47, v96, v53
    v_fma_f32 v96, v46, v52, v110
    v_fma_f32 v97, v46, v53, v111
    v_fma_f32 v96, -v47, v53, v96
    v_fma_f32 v97, v47, v52, v97
    v_fma_f32 v52, v46, v96, v112
    v_fma_f32 v53, v46, v97, v113
    v_fma_f32 v52, -v47, v97, v52
    v_fma_f32 v53, v47, v96, v53
    v_fma_f32 v96, v46, v52, v114
    v_fma_f32 v97, v46, v53, v115
    v_fma_f32 v96, -v47, v53, v96
    v_fma_f32 v97, v47, v52, v97
    s_mov_b64 exec, 0xffffffff
    buffer_store_dwordx4 v[96:99], v26, s[4:7], s47 offen sc1
    s_mov_b64 exec, -1
L_nopub:
    s_sub_u32 s33, s47, 512
    v_lshlrev_b32 v27, 4, v22
    v_add_u32 v26, s33, v27
    v_lshlrev_b32 v28, 9, v23
    v_sub_u32 v26, v26, v28
    s_add_u32 s33, s24, 1
    v_sub_u32 v27, s33, v23
    v_lshrrev_b32 v27, 1, v27
    s_add_u32 s60, s3, 4096
    s_cmp_lg_u32 s29, 0
    s_cbranch_scc1 L_skip0
    v_pk_mul_f32 v[160:161], v[160:161], v[16:17]
    v_pk_mul_f32 v[162:163], v[162:163], v[16:17]
    v_pk_mul_f32 v[164:165], v[164:165], v[16:17]
    v_pk_mul_f32 v[166:167], v[166:167], v[16:17]
    v_readlane_b32 s40, v14, 24
    v_readlane_b32 s41, v14, 25
    s_add_u32 m0, s96, 49152
    s_nop 2
    v_readlane_b32 s42, v14, 26
    buffer_load_dwordx4 v13, s[72:75], s40 offen  lds
    v_pk_mul_f32 v[32:33], v[160:161], v[160:161]
    v_pk_mul_f32 v[34:35], v[162:163], v[162:163]
    v_pk_mul_f32 v[36:37], v[164:165], v[164:165]
    v_pk_mul_f32 v[38:39], v[166:167], v[166:167]
    v_pk_fma_f32 v[32:33], v[32:33], v[62:63], v[60:61]
    v_pk_fma_f32 v[34:35], v[34:35], v[62:63], v[60:61]
    v_pk_fma_f32 v[36:37], v[36:37], v[62:63], v[60:61]
    v_pk_fma_f32 v[38:39], v[38:39], v[62:63], v[60:61]
    v_pk_mul_f32 v[32:33], v[32:33], v[160:161]
    v_pk_mul_f32 v[34:35], v[34:35], v[162:163]
    v_pk_mul_f32 v[36:37], v[36:37], v[164:165]
    v_pk_mul_f32 v[38:39], v[38:39], v[166:167]
    s_add_u32 m0, s96, 53248
    v_readlane_b32 s43, v14, 27
    buffer_load_dwordx4 v13, s[76:79], s41 offen  lds
    v_exp_f32 v32, v32
    v_exp_f32 v33, v33
    v_pk_mul_f32 v[176:177], v[176:177], v[160:161]
    v_exp_f32 v34, v34
    v_exp_f32 v35, v35
    v_pk_mul_f32 v[178:179], v[178:179], v[162:163]
    v_exp_f32 v36, v36
    v_exp_f32 v37, v37
    v_pk_mul_f32 v[180:181], v[180:181], v[164:165]
    v_exp_f32 v38, v38
    v_exp_f32 v39, v39
    v_pk_mul_f32 v[182:183], v[182:183], v[166:167]
    s_add_u32 m0, s96, 57344
    v_readlane_b32 s40, v14, 28
    buffer_load_dwordx4 v13, s[72:75], s42 offen  lds
    v_pk_fma_f32 v[32:33], v[32:33], v[18:19], v[18:19] op_sel_hi:[1,0,0]
    v_pk_fma_f32 v[34:35], v[34:35], v[18:19], v[18:19] op_sel_hi:[1,0,0]
    v_pk_fma_f32 v[36:37], v[36:37], v[18:19], v[18:19] op_sel_hi:[1,0,0]
    v_pk_fma_f32 v[38:39], v[38:39], v[18:19], v[18:19] op_sel_hi:[1,0,0]
    v_rcp_f32 v32, v32
    v_rcp_f32 v33, v33
    v_rcp_f32 v34, v34
    v_rcp_f32 v35, v35
    v_rcp_f32 v36, v36
    v_rcp_f32 v37, v37
    v_rcp_f32 v38, v38
    v_rcp_f32 v39, v39
    s_add_u32 m0, s96, 61440
    v_readlane_b32 s41, v14, 29
    buffer_load_dwordx4 v13, s[76:79], s43 offen  lds
    v_pk_mul_f32 v[176:177], v[176:177], v[32:33]
    v_pk_mul_f32 v[178:179], v[178:179], v[34:35]
    v_pk_mul_f32 v[180:181], v[180:181], v[36:37]
    v_pk_mul_f32 v[182:183], v[182:183], v[38:39]
    v_cvt_pk_bf16_f32 v160, v176, v177
    v_cvt_pk_bf16_f32 v161, v178, v179
    v_cvt_pk_bf16_f32 v162, v180, v181
    v_cvt_pk_bf16_f32 v163, v182, v183
    buffer_store_dwordx4 v[160:163], v15, s[20:23], s3 offen offset:0 sc1
    v_pk_mul_f32 v[168:169], v[168:169], v[16:17]
    v_pk_mul_f32 v[170:171], v[170:171], v[16:17]
    v_pk_mul_f32 v[172:173], v[172:173], v[16:17]
    v_pk_mul_f32 v[174:175], v[174:175], v[16:17]
    s_add_u32 m0, s96, 65536
    v_readlane_b32 s42, v14, 30
    buffer_load_dwordx4 v13, s[72:75], s40 offen  lds
    v_pk_mul_f32 v[32:33], v[168:169], v[168:169]
    v_pk_mul_f32 v[34:35], v[170:171], v[170:171]
    v_pk_mul_f32 v[36:37], v[172:173], v[172:173]
    v_pk_mul_f32 v[38:39], v[174:175], v[174:175]
    v_pk_fma_f32 v[32:33], v[32:33], v[62:63], v[60:61]
    v_pk_fma_f32 v[34:35], v[34:35], v[62:63], v[60:61]
    v_pk_fma_f32 v[36:37], v[36:37], v[62:63], v[60:61]
    v_pk_fma_f32 v[38:39], v[38:39], v[62:63], v[60:61]
    v_pk_mul_f32 v[32:33], v[32:33], v[168:169]
    v_pk_mul_f32 v[34:35], v[34:35], v[170:171]
    v_pk_mul_f32 v[36:37], v[36:37], v[172:173]
    v_pk_mul_f32 v[38:39], v[38:39], v[174:175]
    s_add_u32 m0, s96, 69632
    v_readlane_b32 s43, v14, 31
    buffer_load_dwordx4 v13, s[76:79], s41 offen  lds
    v_exp_f32 v32, v32
    v_exp_f32 v33, v33
    v_pk_mul_f32 v[184:185], v[184:185], v[168:169]
    v_exp_f32 v34, v34
    v_exp_f32 v35, v35
    v_pk_mul_f32 v[186:187], v[186:187], v[170:171]
    v_exp_f32 v36, v36
    v_exp_f32 v37, v37
    v_pk_mul_f32 v[188:189], v[188:189], v[172:173]
    v_exp_f32 v38, v38
    v_exp_f32 v39, v39
    v_pk_mul_f32 v[190:191], v[190:191], v[174:175]
    s_add_u32 m0, s96, 73728
    s_nop 0
    buffer_load_dwordx4 v13, s[72:75], s42 offen  lds
    v_pk_fma_f32 v[32:33], v[32:33], v[18:19], v[18:19] op_sel_hi:[1,0,0]
    v_pk_fma_f32 v[34:35], v[34:35], v[18:19], v[18:19] op_sel_hi:[1,0,0]
    v_pk_fma_f32 v[36:37], v[36:37], v[18:19], v[18:19] op_sel_hi:[1,0,0]
    v_pk_fma_f32 v[38:39], v[38:39], v[18:19], v[18:19] op_sel_hi:[1,0,0]
    v_rcp_f32 v32, v32
    v_rcp_f32 v33, v33
    v_rcp_f32 v34, v34
    v_rcp_f32 v35, v35
    v_rcp_f32 v36, v36
    v_rcp_f32 v37, v37
    v_rcp_f32 v38, v38
    v_rcp_f32 v39, v39
    s_add_u32 m0, s96, 77824
    s_nop 0
    buffer_load_dwordx4 v13, s[76:79], s43 offen  lds
    v_pk_mul_f32 v[184:185], v[184:185], v[32:33]
    v_pk_mul_f32 v[186:187], v[186:187], v[34:35]
    v_pk_mul_f32 v[188:189], v[188:189], v[36:37]
    v_pk_mul_f32 v[190:191], v[190:191], v[38:39]
    v_cvt_pk_bf16_f32 v168, v184, v185
    v_cvt_pk_bf16_f32 v169, v186, v187
    v_cvt_pk_bf16_f32 v170, v188, v189
    v_cvt_pk_bf16_f32 v171, v190, v191
    buffer_store_dwordx4 v[168:171], v15, s[20:23], s3 offen offset:1024 sc1
L_skip0r:
    v_pk_mul_f32 v[192:193], v[192:193], v[16:17]
    v_pk_mul_f32 v[194:195], v[194:195], v[16:17]
    v_pk_mul_f32 v[196:197], v[196:197], v[16:17]
    v_pk_mul_f32 v[198:199], v[198:199], v[16:17]
    v_subrev_u32 v28, 0, v26
    buffer_load_dwordx4 v[160:163], v28, s[4:7], 0 offen sc1
    v_subrev_u32 v28, 1024, v26
    buffer_load_dwordx4 v[164:167], v28, s[4:7], 0 offen sc1
    v_pk_mul_f32 v[32:33], v[192:193], v[192:193]
    v_pk_mul_f32 v[34:35], v[194:195], v[194:195]
    v_pk_mul_f32 v[36:37], v[196:197], v[196:197]
    v_pk_mul_f32 v[38:39], v[198:199], v[198:199]
    v_pk_fma_f32 v[32:33], v[32:33], v[62:63], v[60:61]
    v_pk_fma_f32 v[34:35], v[34:35], v[62:63], v[60:61]
    v_pk_fma_f32 v[36:37], v[36:37], v[62:63], v[60:61]
    v_pk_fma_f32 v[38:39], v[38:39], v[62:63], v[60:61]
    v_pk_mul_f32 v[32:33], v[32:33], v[192:193]
    v_pk_mul_f32 v[34:35], v[34:35], v[194:195]
    v_pk_mul_f32 v[36:37], v[36:37], v[196:197]
    v_pk_mul_f32 v[38:39], v[38:39], v[198:199]
    v_subrev_u32 v28, 2048, v26
    buffer_load_dwordx4 v[168:171], v28, s[4:7], 0 offen sc1
    v_subrev_u32 v28, 3072, v26
    buffer_load_dwordx4 v[172:175], v28, s[4:7], 0 offen sc1
    v_exp_f32 v32, v32
    v_exp_f32 v33, v33
    v_pk_mul_f32 v[208:209], v[208:209], v[192:193]
    v_exp_f32 v34, v34
    v_exp_f32 v35, v35
    v_pk_mul_f32 v[210:211], v[210:211], v[194:195]
    v_exp_f32 v36, v36
    v_exp_f32 v37, v37
    v_pk_mul_f32 v[212:213], v[212:213], v[196:197]
    v_exp_f32 v38, v38
    v_exp_f32 v39, v39
    v_pk_mul_f32 v[214:215], v[214:215], v[198:199]
    v_subrev_u32 v28, 4096, v26
    buffer_load_dwordx4 v[176:179], v28, s[4:7], 0 offen sc1
    v_subrev_u32 v28, 5120, v26
    buffer_load_dwordx4 v[180:183], v28, s[4:7], 0 offen sc1
    v_pk_fma_f32 v[32:33], v[32:33], v[18:19], v[18:19] op_sel_hi:[1,0,0]
    v_pk_fma_f32 v[34:35], v[34:35], v[18:19], v[18:19] op_sel_hi:[1,0,0]
    v_pk_fma_f32 v[36:37], v[36:37], v[18:19], v[18:19] op_sel_hi:[1,0,0]
    v_pk_fma_f32 v[38:39], v[38:39], v[18:19], v[18:19] op_sel_hi:[1,0,0]
    v_rcp_f32 v32, v32
    v_rcp_f32 v33, v33
    v_rcp_f32 v34, v34
    v_rcp_f32 v35, v35
    v_rcp_f32 v36, v36
    v_rcp_f32 v37, v37
    v_rcp_f32 v38, v38
    v_rcp_f32 v39, v39
    v_subrev_u32 v28, 6144, v26
    buffer_load_dwordx4 v[184:187], v28, s[4:7], 0 offen sc1
    v_subrev_u32 v28, 7168, v26
    buffer_load_dwordx4 v[188:191], v28, s[4:7], 0 offen sc1
    v_pk_mul_f32 v[208:209], v[208:209], v[32:33]
    v_pk_mul_f32 v[210:211], v[210:211], v[34:35]
    v_pk_mul_f32 v[212:213], v[212:213], v[36:37]
    v_pk_mul_f32 v[214:215], v[214:215], v[38:39]
    v_cvt_pk_bf16_f32 v192, v208, v209
    v_cvt_pk_bf16_f32 v193, v210, v211
    v_cvt_pk_bf16_f32 v194, v212, v213
    v_cvt_pk_bf16_f32 v195, v214, v215
    buffer_store_dwordx4 v[192:195], v15, s[20:23], s3 offen offset:2048 sc1
    v_pk_mul_f32 v[200:201], v[200:201], v[16:17]
    v_pk_mul_f32 v[202:203], v[202:203], v[16:17]
    v_pk_mul_f32 v[204:205], v[204:205], v[16:17]
    v_pk_mul_f32 v[206:207], v[206:207], v[16:17]
    v_pk_mul_f32 v[32:33], v[200:201], v[200:201]
    v_pk_mul_f32 v[34:35], v[202:203], v[202:203]
    v_pk_mul_f32 v[36:37], v[204:205], v[204:205]
    v_pk_mul_f32 v[38:39], v[206:207], v[206:207]
    v_pk_fma_f32 v[32:33], v[32:33], v[62:63], v[60:61]
    v_pk_fma_f32 v[34:35], v[34:35], v[62:63], v[60:61]
    v_pk_fma_f32 v[36:37], v[36:37], v[62:63], v[60:61]
    v_pk_fma_f32 v[38:39], v[38:39], v[62:63], v[60:61]
    v_pk_mul_f32 v[32:33], v[32:33], v[200:201]
    v_pk_mul_f32 v[34:35], v[34:35], v[202:203]
    v_pk_mul_f32 v[36:37], v[36:37], v[204:205]
    v_pk_mul_f32 v[38:39], v[38:39], v[206:207]
    v_exp_f32 v32, v32
    v_exp_f32 v33, v33
    v_pk_mul_f32 v[216:217], v[216:217], v[200:201]
    v_exp_f32 v34, v34
    v_exp_f32 v35, v35
    v_pk_mul_f32 v[218:219], v[218:219], v[202:203]
    v_exp_f32 v36, v36
    v_exp_f32 v37, v37
    v_pk_mul_f32 v[220:221], v[220:221], v[204:205]
    v_exp_f32 v38, v38
    v_exp_f32 v39, v39
    v_pk_mul_f32 v[222:223], v[222:223], v[206:207]
    v_pk_fma_f32 v[32:33], v[32:33], v[18:19], v[18:19] op_sel_hi:[1,0,0]
    v_pk_fma_f32 v[34:35], v[34:35], v[18:19], v[18:19] op_sel_hi:[1,0,0]
    v_pk_fma_f32 v[36:37], v[36:37], v[18:19], v[18:19] op_sel_hi:[1,0,0]
    v_pk_fma_f32 v[38:39], v[38:39], v[18:19], v[18:19] op_sel_hi:[1,0,0]
    v_rcp_f32 v32, v32
    v_rcp_f32 v33, v33
    v_rcp_f32 v34, v34
    v_rcp_f32 v35, v35
    v_rcp_f32 v36, v36
    v_rcp_f32 v37, v37
    v_rcp_f32 v38, v38
    v_rcp_f32 v39, v39
    v_pk_mul_f32 v[216:217], v[216:217], v[32:33]
    v_pk_mul_f32 v[218:219], v[218:219], v[34:35]
    v_pk_mul_f32 v[220:221], v[220:221], v[36:37]
    v_pk_mul_f32 v[222:223], v[222:223], v[38:39]
    v_cvt_pk_bf16_f32 v200, v216, v217
    v_cvt_pk_bf16_f32 v201, v218, v219
    v_cvt_pk_bf16_f32 v202, v220, v221
    v_cvt_pk_bf16_f32 v203, v222, v223
    buffer_store_dwordx4 v[200:203], v15, s[20:23], s3 offen offset:3072 sc1
    v_pk_mul_f32 v[224:225], v[224:225], v[16:17]
    v_pk_mul_f32 v[226:227], v[226:227], v[16:17]
    v_pk_mul_f32 v[228:229], v[228:229], v[16:17]
    v_pk_mul_f32 v[230:231], v[230:231], v[16:17]
    v_pk_mul_f32 v[32:33], v[224:225], v[224:225]
    v_pk_mul_f32 v[34:35], v[226:227], v[226:227]
    v_pk_mul_f32 v[36:37], v[228:229], v[228:229]
    v_pk_mul_f32 v[38:39], v[230:231], v[230:231]
    v_pk_fma_f32 v[32:33], v[32:33], v[62:63], v[60:61]
    v_pk_fma_f32 v[34:35], v[34:35], v[62:63], v[60:61]
    v_pk_fma_f32 v[36:37], v[36:37], v[62:63], v[60:61]
    v_pk_fma_f32 v[38:39], v[38:39], v[62:63], v[60:61]
    v_pk_mul_f32 v[32:33], v[32:33], v[224:225]
    v_pk_mul_f32 v[34:35], v[34:35], v[226:227]
    v_pk_mul_f32 v[36:37], v[36:37], v[228:229]
    v_pk_mul_f32 v[38:39], v[38:39], v[230:231]
    v_exp_f32 v32, v32
    v_exp_f32 v33, v33
    v_pk_mul_f32 v[240:241], v[240:241], v[224:225]
    v_exp_f32 v34, v34
    v_exp_f32 v35, v35
    v_pk_mul_f32 v[242:243], v[242:243], v[226:227]
    v_exp_f32 v36, v36
    v_exp_f32 v37, v37
    v_pk_mul_f32 v[244:245], v[244:245], v[228:229]
    v_exp_f32 v38, v38
    v_exp_f32 v39, v39
    v_pk_mul_f32 v[246:247], v[246:247], v[230:231]
    v_pk_fma_f32 v[32:33], v[32:33], v[18:19], v[18:19] op_sel_hi:[1,0,0]
    v_pk_fma_f32 v[34:35], v[34:35], v[18:19], v[18:19] op_sel_hi:[1,0,0]
    v_pk_fma_f32 v[36:37], v[36:37], v[18:19], v[18:19] op_sel_hi:[1,0,0]
    v_pk_fma_f32 v[38:39], v[38:39], v[18:19], v[18:19] op_sel_hi:[1,0,0]
    v_rcp_f32 v32, v32
    v_rcp_f32 v33, v33
    v_rcp_f32 v34, v34
    v_rcp_f32 v35, v35
    v_rcp_f32 v36, v36
    v_rcp_f32 v37, v37
    v_rcp_f32 v38, v38
    v_rcp_f32 v39, v39
    v_pk_mul_f32 v[240:241], v[240:241], v[32:33]
    v_pk_mul_f32 v[242:243], v[242:243], v[34:35]
    v_pk_mul_f32 v[244:245], v[244:245], v[36:37]
    v_pk_mul_f32 v[246:247], v[246:247], v[38:39]
    v_cvt_pk_bf16_f32 v224, v240, v241
    v_cvt_pk_bf16_f32 v225, v242, v243
    v_cvt_pk_bf16_f32 v226, v244, v245
    v_cvt_pk_bf16_f32 v227, v246, v247
    buffer_store_dwordx4 v[224:227], v15, s[20:23], s60 offen offset:0 sc1
    v_pk_mul_f32 v[232:233], v[232:233], v[16:17]
    v_pk_mul_f32 v[234:235], v[234:235], v[16:17]
    v_pk_mul_f32 v[236:237], v[236:237], v[16:17]
    v_pk_mul_f32 v[238:239], v[238:239], v[16:17]
    v_pk_mul_f32 v[32:33], v[232:233], v[232:233]
    v_pk_mul_f32 v[34:35], v[234:235], v[234:235]
    v_pk_mul_f32 v[36:37], v[236:237], v[236:237]
    v_pk_mul_f32 v[38:39], v[238:239], v[238:239]
    v_pk_fma_f32 v[32:33], v[32:33], v[62:63], v[60:61]
    v_pk_fma_f32 v[34:35], v[34:35], v[62:63], v[60:61]
    v_pk_fma_f32 v[36:37], v[36:37], v[62:63], v[60:61]
    v_pk_fma_f32 v[38:39], v[38:39], v[62:63], v[60:61]
    v_pk_mul_f32 v[32:33], v[32:33], v[232:233]
    v_pk_mul_f32 v[34:35], v[34:35], v[234:235]
    v_pk_mul_f32 v[36:37], v[36:37], v[236:237]
    v_pk_mul_f32 v[38:39], v[38:39], v[238:239]
    v_exp_f32 v32, v32
    v_exp_f32 v33, v33
    v_pk_mul_f32 v[248:249], v[248:249], v[232:233]
    v_exp_f32 v34, v34
    v_exp_f32 v35, v35
    v_pk_mul_f32 v[250:251], v[250:251], v[234:235]
    v_exp_f32 v36, v36
    v_exp_f32 v37, v37
    v_pk_mul_f32 v[252:253], v[252:253], v[236:237]
    v_exp_f32 v38, v38
    v_exp_f32 v39, v39
    v_pk_mul_f32 v[254:255], v[254:255], v[238:239]
    v_pk_fma_f32 v[32:33], v[32:33], v[18:19], v[18:19] op_sel_hi:[1,0,0]
    v_pk_fma_f32 v[34:35], v[34:35], v[18:19], v[18:19] op_sel_hi:[1,0,0]
    v_pk_fma_f32 v[36:37], v[36:37], v[18:19], v[18:19] op_sel_hi:[1,0,0]
    v_pk_fma_f32 v[38:39], v[38:39], v[18:19], v[18:19] op_sel_hi:[1,0,0]
    v_rcp_f32 v32, v32
    v_rcp_f32 v33, v33
    v_rcp_f32 v34, v34
    v_rcp_f32 v35, v35
    v_rcp_f32 v36, v36
    v_rcp_f32 v37, v37
    v_rcp_f32 v38, v38
    v_rcp_f32 v39, v39
    v_pk_mul_f32 v[248:249], v[248:249], v[32:33]
    v_pk_mul_f32 v[250:251], v[250:251], v[34:35]
    v_pk_mul_f32 v[252:253], v[252:253], v[36:37]
    v_pk_mul_f32 v[254:255], v[254:255], v[38:39]
    v_cvt_pk_bf16_f32 v232, v248, v249
    v_cvt_pk_bf16_f32 v233, v250, v251
    v_cvt_pk_bf16_f32 v234, v252, v253
    v_cvt_pk_bf16_f32 v235, v254, v255
    buffer_store_dwordx4 v[232:235], v15, s[20:23], s60 offen offset:1024 sc1
    s_waitcnt vmcnt(4)
    s_waitcnt lgkmcnt(0)
    v_mov_b32 v29, 0
    v_cmp_eq_u32 s[48:49], s27, v162
    v_cmp_eq_u32 s[50:51], s27, v166
    v_cmp_eq_u32 s[52:53], s27, v170
    v_addc_co_u32 v29, vcc, 0, v29, s[48:49]
    v_cmp_eq_u32 s[48:49], s27, v174
    v_addc_co_u32 v29, vcc, 0, v29, s[50:51]
    v_cmp_eq_u32 s[50:51], s27, v178
    v_addc_co_u32 v29, vcc, 0, v29, s[52:53]
    v_cmp_eq_u32 s[52:53], s27, v182
    v_addc_co_u32 v29, vcc, 0, v29, s[48:49]
    v_cmp_eq_u32 s[48:49], s27, v186
    v_addc_co_u32 v29, vcc, 0, v29, s[50:51]
    v_cmp_eq_u32 s[50:51], s27, v190
    v_addc_co_u32 v29, vcc, 0, v29, s[52:53]
    s_nop 0
    v_addc_co_u32 v29, vcc, 0, v29, s[48:49]
    s_nop 0
    v_addc_co_u32 v29, vcc, 0, v29, s[50:51]
    v_cmp_ne_u32 vcc, v27, v29
    s_cbranch_vccnz L_t_slow
L_t_ok:
    v_fma_f32 v54, v58, v188, v184
    v_fma_f32 v55, v58, v189, v185
    v_fma_f32 v54, -v59, v189, v54
    v_fma_f32 v55, v59, v188, v55
    v_fma_f32 v52, v58, v54, v180
    v_fma_f32 v53, v58, v55, v181
    v_fma_f32 v52, -v59, v55, v52
    v_fma_f32 v53, v59, v54, v53
    v_fma_f32 v54, v58, v52, v176
    v_fma_f32 v55, v58, v53, v177
    v_fma_f32 v54, -v59, v53, v54
    v_fma_f32 v55, v59, v52, v55
    v_fma_f32 v52, v58, v54, v172
    v_fma_f32 v53, v58, v55, v173
    v_fma_f32 v52, -v59, v55, v52
    v_fma_f32 v53, v59, v54, v53
    v_fma_f32 v54, v58, v52, v168
    v_fma_f32 v55, v58, v53, v169
    v_fma_f32 v54, -v59, v53, v54
    v_fma_f32 v55, v59, v52, v55
    v_fma_f32 v52, v58, v54, v164
    v_fma_f32 v53, v58, v55, v165
    v_fma_f32 v52, -v59, v55, v52
    v_fma_f32 v53, v59, v54, v53
    v_fma_f32 v54, v58, v52, v160
    v_fma_f32 v55, v58, v53, v161
    v_fma_f32 v54, -v59, v53, v54
    v_fma_f32 v55, v59, v52, v55
    v_mov_b32 v56, v54
    v_mov_b32 v57, v55
    s_lshl_b32 s33, s97, 11
    s_lshl_b32 s44, s25, 7
    v_permlane32_swap_b32 v54, v56
    v_permlane32_swap_b32 v55, v57
    s_add_u32 s44, s44, s33
    s_add_u32 s33, s44, 22020096
    v_mov_b32 v20, s27
    v_mov_b32 v21, 0
    s_waitcnt vmcnt(0)
    s_mov_b64 exec, 1
    buffer_store_dword v20, v21, s[20:23], s33 offen sc1
    s_mov_b64 exec, -1
    v_fma_f32 v52, v48, v56, v54
    v_fma_f32 v53, v48, v57, v55
    v_fma_f32 v52, -v49, v57, v52
    v_fma_f32 v53, v49, v56, v53
    s_lshl_b32 s33, s26, 1
    v_add_u32 v26, s33, v23
    v_mov_b32 v56, v52
    v_mov_b32 v57, v53
    v_cmp_eq_u32 vcc, 1, v26
    v_fma_f32 v54, v46, v52, v100
    v_fma_f32 v55, v46, v53, v101
    v_fma_f32 v54, -v47, v53, v54
    v_fma_f32 v55, v47, v52, v55
    v_cndmask_b32 v56, v56, v54, vcc
    v_cndmask_b32 v57, v57, v55, vcc
    v_cmp_eq_u32 vcc, 2, v26
    v_fma_f32 v52, v46, v54, v102
    v_fma_f32 v53, v46, v55, v103
    v_fma_f32 v52, -v47, v55, v52
    v_fma_f32 v53, v47, v54, v53
    v_cndmask_b32 v56, v56, v52, vcc
    v_cndmask_b32 v57, v57, v53, vcc
    v_cmp_eq_u32 vcc, 3, v26
    v_fma_f32 v54, v46, v52, v104
    v_fma_f32 v55, v46, v53, v105
    v_fma_f32 v54, -v47, v53, v54
    v_fma_f32 v55, v47, v52, v55
    v_cndmask_b32 v56, v56, v54, vcc
    v_cndmask_b32 v57, v57, v55, vcc
    v_cmp_eq_u32 vcc, 4, v26
    v_fma_f32 v52, v46, v54, v106
    v_fma_f32 v53, v46, v55, v107
    v_fma_f32 v52, -v47, v55, v52
    v_fma_f32 v53, v47, v54, v53
    v_cndmask_b32 v56, v56, v52, vcc
    v_cndmask_b32 v57, v57, v53, vcc
    v_cmp_eq_u32 vcc, 5, v26
    v_fma_f32 v54, v46, v52, v108
    v_fma_f32 v55, v46, v53, v109
    v_fma_f32 v54, -v47, v53, v54
    v_fma_f32 v55, v47, v52, v55
    v_cndmask_b32 v56, v56, v54, vcc
    v_cndmask_b32 v57, v57, v55, vcc
    v_cmp_eq_u32 vcc, 6, v26
    v_fma_f32 v52, v46, v54, v110
    v_fma_f32 v53, v46, v55, v111
    v_fma_f32 v52, -v47, v55, v52
    v_fma_f32 v53, v47, v54, v53
    v_cndmask_b32 v56, v56, v52, vcc
    v_cndmask_b32 v57, v57, v53, vcc
    v_cmp_eq_u32 vcc, 7, v26
    v_fma_f32 v54, v46, v52, v112
    v_fma_f32 v55, v46, v53, v113
    v_fma_f32 v54, -v47, v53, v54
    v_fma_f32 v55, v47, v52, v55
    v_cndmask_b32 v56, v56, v54, vcc
    v_cndmask_b32 v57, v57, v55, vcc
    v_lshlrev_b32 v24, 6, v22
    v_lshl_add_u32 v24, v23, 5, v24
    s_add_u32 s33, s37, 81920
    v_add_u32 v24, s33, v24
    v_bfe_u32 v25, v0, 2, 2
    v_lshl_add_u32 v25, v23, 3, v25
    v_lshlrev_b32 v25, 6, v25
    v_and_b32 v26, 1, v0
    v_lshl_add_u32 v25, v26, 5, v25
    v_bfe_u32 v26, v0, 4, 1
    v_lshl_add_u32 v25, v26, 4, v25
    v_bfe_u32 v26, v0, 1, 1
    v_lshl_add_u32 v25, v26, 3, v25
    v_add_u32 v25, s33, v25
    v_fma_f32 v128, v44, v56, v128
    v_fma_f32 v144, v44, v57, v144
    v_fma_f32 v128, -v45, v57, v128
    v_fma_f32 v144, v45, v56, v144
    v_fma_f32 v129, v44, v128, v129
    v_fma_f32 v145, v44, v144, v145
    v_fma_f32 v129, -v45, v144, v129
    v_fma_f32 v145, v45, v128, v145
    v_fma_f32 v130, v44, v129, v130
    v_fma_f32 v146, v44, v145, v146
    v_fma_f32 v130, -v45, v145, v130
    v_fma_f32 v146, v45, v129, v146
    v_pk_mul_f32 v[160:161], v[128:129], v[50:51] op_sel_hi:[1,0]
    v_pk_mul_f32 v[176:177], v[144:145], v[50:51] op_sel_hi:[1,0]
    v_pk_fma_f32 v[160:161], v[144:145], v[40:41], v[160:161] op_sel_hi:[1,0,1] neg_lo:[0,1,0] neg_hi:[0,1,0]
    v_pk_fma_f32 v[176:177], v[128:129], v[40:41], v[176:177] op_sel_hi:[1,0,1] neg_lo:[0,1,1] neg_hi:[0,1,1]
    v_fma_f32 v131, v44, v130, v131
    v_fma_f32 v147, v44, v146, v147
    v_fma_f32 v131, -v45, v146, v131
    v_fma_f32 v147, v45, v130, v147
    v_fma_f32 v132, v44, v131, v132
    v_fma_f32 v148, v44, v147, v148
    v_fma_f32 v132, -v45, v147, v132
    v_fma_f32 v148, v45, v131, v148
    v_pk_mul_f32 v[162:163], v[130:131], v[50:51] op_sel_hi:[1,0]
    v_pk_mul_f32 v[178:179], v[146:147], v[50:51] op_sel_hi:[1,0]
    v_pk_fma_f32 v[162:163], v[146:147], v[40:41], v[162:163] op_sel_hi:[1,0,1] neg_lo:[0,1,0] neg_hi:[0,1,0]
    v_pk_fma_f32 v[178:179], v[130:131], v[40:41], v[178:179] op_sel_hi:[1,0,1] neg_lo:[0,1,1] neg_hi:[0,1,1]
    v_cvt_pk_bf16_f32 v96, v160, v161
    v_cvt_pk_bf16_f32 v104, v176, v177
    v_fma_f32 v133, v44, v132, v133
    v_fma_f32 v149, v44, v148, v149
    v_fma_f32 v133, -v45, v148, v133
    v_fma_f32 v149, v45, v132, v149
    v_fma_f32 v134, v44, v133, v134
    v_fma_f32 v150, v44, v149, v150
    v_fma_f32 v134, -v45, v149, v134
    v_fma_f32 v150, v45, v133, v150
    v_pk_mul_f32 v[164:165], v[132:133], v[50:51] op_sel_hi:[1,0]
    v_pk_mul_f32 v[180:181], v[148:149], v[50:51] op_sel_hi:[1,0]
    v_pk_fma_f32 v[164:165], v[148:149], v[40:41], v[164:165] op_sel_hi:[1,0,1] neg_lo:[0,1,0] neg_hi:[0,1,0]
    v_pk_fma_f32 v[180:181], v[132:133], v[40:41], v[180:181] op_sel_hi:[1,0,1] neg_lo:[0,1,1] neg_hi:[0,1,1]
    v_cvt_pk_bf16_f32 v97, v162, v163
    v_cvt_pk_bf16_f32 v105, v178, v179
    v_fma_f32 v135, v44, v134, v135
    v_fma_f32 v151, v44, v150, v151
    v_fma_f32 v135, -v45, v150, v135
    v_fma_f32 v151, v45, v134, v151
    v_fma_f32 v136, v44, v135, v136
    v_fma_f32 v152, v44, v151, v152
    v_fma_f32 v136, -v45, v151, v136
    v_fma_f32 v152, v45, v135, v152
    v_pk_mul_f32 v[166:167], v[134:135], v[50:51] op_sel_hi:[1,0]
    v_pk_mul_f32 v[182:183], v[150:151], v[50:51] op_sel_hi:[1,0]
    v_pk_fma_f32 v[166:167], v[150:151], v[40:41], v[166:167] op_sel_hi:[1,0,1] neg_lo:[0,1,0] neg_hi:[0,1,0]
    v_pk_fma_f32 v[182:183], v[134:135], v[40:41], v[182:183] op_sel_hi:[1,0,1] neg_lo:[0,1,1] neg_hi:[0,1,1]
    v_cvt_pk_bf16_f32 v98, v164, v165
    v_cvt_pk_bf16_f32 v106, v180, v181
    v_fma_f32 v137, v44, v136, v137
    v_fma_f32 v153, v44, v152, v153
    v_fma_f32 v137, -v45, v152, v137
    v_fma_f32 v153, v45, v136, v153
    v_fma_f32 v138, v44, v137, v138
    v_fma_f32 v154, v44, v153, v154
    v_fma_f32 v138, -v45, v153, v138
    v_fma_f32 v154, v45, v137, v154
    v_pk_mul_f32 v[168:169], v[136:137], v[50:51] op_sel_hi:[1,0]
    v_pk_mul_f32 v[184:185], v[152:153], v[50:51] op_sel_hi:[1,0]
    v_pk_fma_f32 v[168:169], v[152:153], v[40:41], v[168:169] op_sel_hi:[1,0,1] neg_lo:[0,1,0] neg_hi:[0,1,0]
    v_pk_fma_f32 v[184:185], v[136:137], v[40:41], v[184:185] op_sel_hi:[1,0,1] neg_lo:[0,1,1] neg_hi:[0,1,1]
    v_cvt_pk_bf16_f32 v99, v166, v167
    v_cvt_pk_bf16_f32 v107, v182, v183
    v_fma_f32 v139, v44, v138, v139
    v_fma_f32 v155, v44, v154, v155
    v_fma_f32 v139, -v45, v154, v139
    v_fma_f32 v155, v45, v138, v155
    ds_write_b128 v24, v[96:99] offset:0
    ds_write_b128 v24, v[104:107] offset:2048
    v_fma_f32 v140, v44, v139, v140
    v_fma_f32 v156, v44, v155, v156
    v_fma_f32 v140, -v45, v155, v140
    v_fma_f32 v156, v45, v139, v156
    v_pk_mul_f32 v[170:171], v[138:139], v[50:51] op_sel_hi:[1,0]
    v_pk_mul_f32 v[186:187], v[154:155], v[50:51] op_sel_hi:[1,0]
    v_pk_fma_f32 v[170:171], v[154:155], v[40:41], v[170:171] op_sel_hi:[1,0,1] neg_lo:[0,1,0] neg_hi:[0,1,0]
    v_pk_fma_f32 v[186:187], v[138:139], v[40:41], v[186:187] op_sel_hi:[1,0,1] neg_lo:[0,1,1] neg_hi:[0,1,1]
    v_cvt_pk_bf16_f32 v100, v168, v169
    v_cvt_pk_bf16_f32 v108, v184, v185
    v_fma_f32 v141, v44, v140, v141
    v_fma_f32 v157, v44, v156, v157
    v_fma_f32 v141, -v45, v156, v141
    v_fma_f32 v157, v45, v140, v157
    v_fma_f32 v142, v44, v141, v142
    v_fma_f32 v158, v44, v157, v158
    v_fma_f32 v142, -v45, v157, v142
    v_fma_f32 v158, v45, v141, v158
    v_pk_mul_f32 v[172:173], v[140:141], v[50:51] op_sel_hi:[1,0]
    v_pk_mul_f32 v[188:189], v[156:157], v[50:51] op_sel_hi:[1,0]
    v_pk_fma_f32 v[172:173], v[156:157], v[40:41], v[172:173] op_sel_hi:[1,0,1] neg_lo:[0,1,0] neg_hi:[0,1,0]
    v_pk_fma_f32 v[188:189], v[140:141], v[40:41], v[188:189] op_sel_hi:[1,0,1] neg_lo:[0,1,1] neg_hi:[0,1,1]
    v_cvt_pk_bf16_f32 v101, v170, v171
    v_cvt_pk_bf16_f32 v109, v186, v187
    v_fma_f32 v143, v44, v142, v143
    v_fma_f32 v159, v44, v158, v159
    v_fma_f32 v143, -v45, v158, v143
    v_fma_f32 v159, v45, v142, v159
    v_pk_mul_f32 v[174:175], v[142:143], v[50:51] op_sel_hi:[1,0]
    v_pk_mul_f32 v[190:191], v[158:159], v[50:51] op_sel_hi:[1,0]
    v_pk_fma_f32 v[174:175], v[158:159], v[40:41], v[174:175] op_sel_hi:[1,0,1] neg_lo:[0,1,0] neg_hi:[0,1,0]
    v_pk_fma_f32 v[190:191], v[142:143], v[40:41], v[190:191] op_sel_hi:[1,0,1] neg_lo:[0,1,1] neg_hi:[0,1,1]
    v_cvt_pk_bf16_f32 v102, v172, v173
    v_cvt_pk_bf16_f32 v110, v188, v189
    v_cvt_pk_bf16_f32 v103, v174, v175
    v_cvt_pk_bf16_f32 v111, v190, v191
    ds_write_b128 v24, v[100:103] offset:16
    ds_write_b128 v24, v[108:111] offset:2064
    s_lshl_b32 s33, s25, 12
    s_add_u32 s33, s33, 88064
    s_add_u32 s33, s33, s45
    s_waitcnt lgkmcnt(0)
    ds_read_b64_tr_b16 v[112:113], v25 offset:0
    ds_read_b64_tr_b16 v[114:115], v25 offset:256
    ds_read_b64_tr_b16 v[116:117], v25 offset:1024
    ds_read_b64_tr_b16 v[118:119], v25 offset:1280
    ds_read_b64_tr_b16 v[120:121], v25 offset:2048
    ds_read_b64_tr_b16 v[122:123], v25 offset:2304
    ds_read_b64_tr_b16 v[124:125], v25 offset:3072
    ds_read_b64_tr_b16 v[126:127], v25 offset:3328
    s_waitcnt lgkmcnt(6)
    buffer_store_dwordx4 v[112:115], v15, s[20:23], s33 offen offset:0 sc1
    s_waitcnt lgkmcnt(4)
    buffer_store_dwordx4 v[116:119], v15, s[20:23], s33 offen offset:1024 sc1
    s_waitcnt lgkmcnt(2)
    buffer_store_dwordx4 v[120:123], v15, s[20:23], s33 offen offset:2048 sc1
    s_waitcnt lgkmcnt(0)
    buffer_store_dwordx4 v[124:127], v15, s[20:23], s33 offen offset:3072 sc1
    s_lshl_b32 s33, s31, 2
    s_add_u32 s97, s33, s26
    s_mul_i32 s45, s97, 153600
    s_add_u32 s45, s45, 4194304
    s_lshl_b32 s34, s31, 3
    s_add_u32 s34, s34, s32
    s_lshl_b32 s34, s34, 2
    s_add_u32 s34, s34, s26
    s_lshl_b32 s35, s34, 7
    s_add_u32 s35, s35, 20971520
    s_lshl_b32 s34, s34, 13
    s_add_u32 s34, s34, 16777216
    s_lshl_b32 s36, s97, 11
    s_cmp_eq_u32 s30, 0
    s_cselect_b32 s33, 23068672, 0
    s_cselect_b32 s3, 0, 22020096
    s_add_u32 s36, s36, s33
    s_add_u32 s36, s36, s3
    v_and_b32 v2, 15, v0
    v_lshlrev_b32 v2, 7, v2
    s_mov_b64 exec, 0xffff
    v_mov_b32 v3, 0
    buffer_atomic_or v3, v2, s[20:23], s36 offen sc0 sc1
    s_mov_b64 exec, -1
    s_cmp_eq_u32 s30, 0
    s_cbranch_scc1 L_nox
    s_add_u32 s33, s37, 81920
    v_add_u32 v4, s33, v15
    v_and_b32 v22, 31, v0
    v_lshrrev_b32 v23, 5, v0
    v_lshlrev_b32 v24, 1, v22
    v_lshl_add_u32 v11, v23, 14, v24
    v_lshl_add_u32 v12, v23, 11, v24
    v_add_u32 v12, s33, v12
    s_lshl_b32 s33, s26, 8
    s_add_u32 s33, s33, 147456
    v_lshl_add_u32 v7, v22, 2, s33
    v_lshl_add_u32 v5, v23, 6, s33
    ds_write2_b32 v7, v30, v31 offset0:0 offset1:32
    ds_write_b128 v4, a[104:107] offset:0
    ds_write_b128 v4, a[108:111] offset:1024
    ds_write_b128 v4, a[112:115] offset:2048
    ds_write_b128 v4, a[116:119] offset:3072
    ds_read_b128 v[224:227], v5 offset:0
    ds_read_b128 v[228:231], v5 offset:16
    ds_read_b128 v[232:235], v5 offset:32
    ds_read_b128 v[236:239], v5 offset:48
    ds_read_b128 v[240:243], v5 offset:128
    ds_read_b128 v[244:247], v5 offset:144
    ds_read_b128 v[248:251], v5 offset:160
    ds_read_b128 v[252:255], v5 offset:176
    s_waitcnt lgkmcnt(6)
    v_accvgpr_read_b32 v6, a120
    v_accvgpr_read_b32 v4, a121
    ds_read_u16 v64, v12 offset:0
    ds_read_u16 v65, v12 offset:128
    ds_read_u16 v66, v12 offset:256
    ds_read_u16 v67, v12 offset:384
    ds_read_u16 v68, v12 offset:512
    ds_read_u16 v69, v12 offset:640
    ds_read_u16 v70, v12 offset:768
    ds_read_u16 v71, v12 offset:896
    s_waitcnt lgkmcnt(6)
    ds_read_u16 v72, v12 offset:1024
    ds_read_u16 v73, v12 offset:1152
    ds_read_u16 v74, v12 offset:1280
    ds_read_u16 v75, v12 offset:1408
    ds_read_u16 v76, v12 offset:1536
    ds_read_u16 v77, v12 offset:1664
    ds_read_u16 v78, v12 offset:1792
    ds_read_u16 v79, v12 offset:1920
    s_waitcnt lgkmcnt(6)
    ds_read_u16 v80, v12 offset:64
    ds_read_u16 v81, v12 offset:192
    ds_read_u16 v82, v12 offset:320
    ds_read_u16 v83, v12 offset:448
    ds_read_u16 v84, v12 offset:576
    ds_read_u16 v85, v12 offset:704
    ds_read_u16 v86, v12 offset:832
    ds_read_u16 v87, v12 offset:960
    s_waitcnt lgkmcnt(6)
    ds_read_u16 v88, v12 offset:1088
    ds_read_u16 v89, v12 offset:1216
    ds_read_u16 v90, v12 offset:1344
    ds_read_u16 v91, v12 offset:1472
    ds_read_u16 v92, v12 offset:1600
    ds_read_u16 v93, v12 offset:1728
    ds_read_u16 v94, v12 offset:1856
    ds_read_u16 v95, v12 offset:1984
    s_waitcnt lgkmcnt(6)
    v_lshlrev_b32 v64, 16, v64
    v_lshlrev_b32 v65, 16, v65
    v_lshlrev_b32 v66, 16, v66
    v_lshlrev_b32 v67, 16, v67
    v_lshlrev_b32 v68, 16, v68
    v_lshlrev_b32 v69, 16, v69
    v_lshlrev_b32 v70, 16, v70
    v_lshlrev_b32 v71, 16, v71
    v_lshlrev_b32 v72, 16, v72
    v_lshlrev_b32 v73, 16, v73
    v_lshlrev_b32 v74, 16, v74
    v_lshlrev_b32 v75, 16, v75
    v_lshlrev_b32 v76, 16, v76
    v_lshlrev_b32 v77, 16, v77
    v_lshlrev_b32 v78, 16, v78
    v_lshlrev_b32 v79, 16, v79
    v_pk_add_f32 v[192:193], v[64:65], v[224:225] neg_lo:[0,1] neg_hi:[0,1]
    v_pk_add_f32 v[194:195], v[66:67], v[226:227] neg_lo:[0,1] neg_hi:[0,1]
    v_pk_add_f32 v[196:197], v[68:69], v[228:229] neg_lo:[0,1] neg_hi:[0,1]
    v_pk_add_f32 v[198:199], v[70:71], v[230:231] neg_lo:[0,1] neg_hi:[0,1]
    v_pk_add_f32 v[200:201], v[72:73], v[232:233] neg_lo:[0,1] neg_hi:[0,1]
    v_pk_add_f32 v[202:203], v[74:75], v[234:235] neg_lo:[0,1] neg_hi:[0,1]
    v_pk_add_f32 v[204:205], v[76:77], v[236:237] neg_lo:[0,1] neg_hi:[0,1]
    v_pk_add_f32 v[206:207], v[78:79], v[238:239] neg_lo:[0,1] neg_hi:[0,1]
    v_pk_mul_f32 v[192:193], v[192:193], v[240:241]
    v_pk_mul_f32 v[194:195], v[194:195], v[242:243]
    v_pk_mul_f32 v[196:197], v[196:197], v[244:245]
    v_pk_mul_f32 v[198:199], v[198:199], v[246:247]
    v_pk_mul_f32 v[200:201], v[200:201], v[248:249]
    v_pk_mul_f32 v[202:203], v[202:203], v[250:251]
    v_pk_mul_f32 v[204:205], v[204:205], v[252:253]
    v_pk_mul_f32 v[206:207], v[206:207], v[254:255]
    v_pk_mul_f32 v[192:193], v[192:193], v[6:7] op_sel_hi:[1,0]
    v_pk_mul_f32 v[194:195], v[194:195], v[6:7] op_sel_hi:[1,0]
    v_pk_mul_f32 v[196:197], v[196:197], v[6:7] op_sel_hi:[1,0]
    v_pk_mul_f32 v[198:199], v[198:199], v[6:7] op_sel_hi:[1,0]
    v_pk_mul_f32 v[200:201], v[200:201], v[6:7] op_sel_hi:[1,0]
    v_pk_mul_f32 v[202:203], v[202:203], v[6:7] op_sel_hi:[1,0]
    v_pk_mul_f32 v[204:205], v[204:205], v[6:7] op_sel_hi:[1,0]
    v_pk_mul_f32 v[206:207], v[206:207], v[6:7] op_sel_hi:[1,0]
    s_waitcnt lgkmcnt(0)
    v_lshlrev_b32 v80, 16, v80
    v_lshlrev_b32 v81, 16, v81
    v_lshlrev_b32 v82, 16, v82
    v_lshlrev_b32 v83, 16, v83
    v_lshlrev_b32 v84, 16, v84
    v_lshlrev_b32 v85, 16, v85
    v_lshlrev_b32 v86, 16, v86
    v_lshlrev_b32 v87, 16, v87
    v_lshlrev_b32 v88, 16, v88
    v_lshlrev_b32 v89, 16, v89
    v_lshlrev_b32 v90, 16, v90
    v_lshlrev_b32 v91, 16, v91
    v_lshlrev_b32 v92, 16, v92
    v_lshlrev_b32 v93, 16, v93
    v_lshlrev_b32 v94, 16, v94
    v_lshlrev_b32 v95, 16, v95
    v_pk_add_f32 v[208:209], v[80:81], v[224:225] neg_lo:[0,1] neg_hi:[0,1]
    v_pk_add_f32 v[210:211], v[82:83], v[226:227] neg_lo:[0,1] neg_hi:[0,1]
    v_pk_add_f32 v[212:213], v[84:85], v[228:229] neg_lo:[0,1] neg_hi:[0,1]
    v_pk_add_f32 v[214:215], v[86:87], v[230:231] neg_lo:[0,1] neg_hi:[0,1]
    v_pk_add_f32 v[216:217], v[88:89], v[232:233] neg_lo:[0,1] neg_hi:[0,1]
    v_pk_add_f32 v[218:219], v[90:91], v[234:235] neg_lo:[0,1] neg_hi:[0,1]
    v_pk_add_f32 v[220:221], v[92:93], v[236:237] neg_lo:[0,1] neg_hi:[0,1]
    v_pk_add_f32 v[222:223], v[94:95], v[238:239] neg_lo:[0,1] neg_hi:[0,1]
    v_pk_mul_f32 v[208:209], v[208:209], v[240:241]
    v_pk_mul_f32 v[210:211], v[210:211], v[242:243]
    v_pk_mul_f32 v[212:213], v[212:213], v[244:245]
    v_pk_mul_f32 v[214:215], v[214:215], v[246:247]
    v_pk_mul_f32 v[216:217], v[216:217], v[248:249]
    v_pk_mul_f32 v[218:219], v[218:219], v[250:251]
    v_pk_mul_f32 v[220:221], v[220:221], v[252:253]
    v_pk_mul_f32 v[222:223], v[222:223], v[254:255]
    v_pk_mul_f32 v[208:209], v[208:209], v[4:5] op_sel_hi:[1,0]
    v_pk_mul_f32 v[210:211], v[210:211], v[4:5] op_sel_hi:[1,0]
    v_pk_mul_f32 v[212:213], v[212:213], v[4:5] op_sel_hi:[1,0]
    v_pk_mul_f32 v[214:215], v[214:215], v[4:5] op_sel_hi:[1,0]
    v_pk_mul_f32 v[216:217], v[216:217], v[4:5] op_sel_hi:[1,0]
    v_pk_mul_f32 v[218:219], v[218:219], v[4:5] op_sel_hi:[1,0]
    v_pk_mul_f32 v[220:221], v[220:221], v[4:5] op_sel_hi:[1,0]
    v_pk_mul_f32 v[222:223], v[222:223], v[4:5] op_sel_hi:[1,0]
L_nox:
    s_cmp_eq_u32 s30, 0
    s_cbranch_scc1 L_adrY
    v_lshlrev_b32 v22, 9, v23
    v_bfe_u32 v23, v0, 2, 2
    v_lshl_add_u32 v22, v23, 6, v22
    v_bfe_u32 v23, v0, 4, 1
    v_lshl_add_u32 v22, v23, 5, v22
    v_and_b32 v23, 3, v0
    v_lshl_add_u32 v8, v23, 3, v22
    v_add_u32 v9, 0x10000, v8
    v_add_u32 v10, 0x20000, v8
    s_lshl_b32 s33, s101, 11
    s_add_u32 s38, s33, s45
    s_add_u32 s39, s45, 86016
    s_branch L_adrJ
L_adrY:
    v_mov_b32 v4, v68
    v_add_u32 v8, 0x10000, v68
    v_add_u32 v16, 0x20000, v68
    v_mov_b32 v5, v69
    v_add_u32 v9, 0x10000, v69
    v_add_u32 v17, 0x20000, v69
    v_mov_b32 v6, v70
    v_add_u32 v10, 0x10000, v70
    v_add_u32 v18, 0x20000, v70
    v_mov_b32 v7, v71
    v_add_u32 v11, 0x10000, v71
    v_add_u32 v19, 0x20000, v71
    s_add_u32 s45, s45, 88064
    s_lshl_b32 s33, s101, 13
    s_add_u32 s38, s33, s45
L_adrJ:
    s_add_u32 s33, s44, 23068672
    s_waitcnt vmcnt(1)
    s_mov_b64 exec, 1
    buffer_store_dword v20, v21, s[20:23], s33 offen sc1
    s_mov_b64 exec, 0xffff
    s_mov_b64 exec, -1
    s_barrier
    s_cmp_eq_u32 s30, 0
    s_cbranch_scc1 L_norf
    v_readlane_b32 s40, v14, 35
    v_readlane_b32 s41, v14, 36
    s_add_u32 m0, s96, 81920
    s_nop 2
    v_readlane_b32 s42, v14, 37
    buffer_load_dwordx4 v13, s[76:79], s40 offen  lds
    s_add_u32 m0, s96, 86016
    v_readlane_b32 s43, v14, 38
    buffer_load_dwordx4 v13, s[72:75], s41 offen  lds
    s_add_u32 m0, s96, 90112
    v_readlane_b32 s40, v14, 39
    buffer_load_dwordx4 v13, s[76:79], s42 offen  lds
    s_add_u32 m0, s96, 94208
    s_nop 0
    buffer_load_dwordx4 v13, s[72:75], s43 offen  lds
    s_add_u32 m0, s96, 147456
    s_nop 0
    buffer_load_dwordx4 v13, s[76:79], s40 offen  lds
    s_waitcnt vmcnt(6)
    s_branch L_rfj
L_norf:
    s_waitcnt vmcnt(1)
L_rfj:
    s_mov_b64 exec, 0xffff
    v_cmp_ne_u32 vcc, s27, v3
    s_cbranch_vccz L_pollAx
L_pollA:
    s_sleep 2
    v_mov_b32 v3, 0
    buffer_atomic_or v3, v2, s[20:23], s36 offen sc0 sc1
    s_waitcnt vmcnt(0)
    v_cmp_ne_u32 vcc, s27, v3
    s_cbranch_vccnz L_pollA
L_pollAx:
    s_mov_b64 exec, -1
    s_cmp_eq_u32 s30, 0
    s_cbranch_scc1 L_roleY
    buffer_load_dwordx4 a[0:3], v15, s[20:23], s38 offen offset:0 sc1
    buffer_load_dwordx4 a[4:7], v15, s[20:23], s38 offen offset:1024 sc1
    buffer_load_dwordx4 a[8:11], v15, s[20:23], s38 offen offset:2048 sc1
    buffer_load_dwordx4 a[12:15], v15, s[20:23], s38 offen offset:3072 sc1
    s_add_u32 s38, s38, 4096
    s_cmp_ge_u32 s38, s39
    s_cselect_b32 s38, s45, s38
    buffer_load_dwordx4 a[16:19], v15, s[20:23], s38 offen offset:0 sc1
    buffer_load_dwordx4 a[20:23], v15, s[20:23], s38 offen offset:1024 sc1
    buffer_load_dwordx4 a[24:27], v15, s[20:23], s38 offen offset:2048 sc1
    buffer_load_dwordx4 a[28:31], v15, s[20:23], s38 offen offset:3072 sc1
    s_add_u32 s38, s38, 4096
    s_cmp_ge_u32 s38, s39
    s_cselect_b32 s38, s45, s38
    buffer_load_dwordx4 a[32:35], v15, s[20:23], s38 offen offset:0 sc1
    buffer_load_dwordx4 a[36:39], v15, s[20:23], s38 offen offset:1024 sc1
    ds_read_b64_tr_b16 a[96:97], v9 offset:32768
    ds_read_b64_tr_b16 a[98:99], v9 offset:33792
    ds_read_b64_tr_b16 a[100:101], v9 offset:33024
    ds_read_b64_tr_b16 a[102:103], v9 offset:34048
    ds_read_b64_tr_b16 a[104:105], v9 offset:34816
    ds_read_b64_tr_b16 a[106:107], v9 offset:35840
    ds_read_b64_tr_b16 a[108:109], v9 offset:35072
    ds_read_b64_tr_b16 a[110:111], v9 offset:36096
    s_waitcnt vmcnt(9) lgkmcnt(4)
    v_mfma_f32_32x32x16_bf16 v[128:143], a[0:3], a[96:99], 0
    ds_read_b64_tr_b16 a[112:113], v9 offset:36864
    ds_read_b64_tr_b16 a[114:115], v9 offset:37888
    ds_read_b64_tr_b16 a[116:117], v9 offset:37120
    ds_read_b64_tr_b16 a[118:119], v9 offset:38144
    v_mfma_f32_32x32x16_bf16 v[144:159], a[0:3], a[100:103], 0
    buffer_load_dwordx4 a[40:43], v15, s[20:23], s38 offen offset:2048 sc1
    buffer_load_dwordx4 a[44:47], v15, s[20:23], s38 offen offset:3072 sc1
    s_waitcnt vmcnt(10) lgkmcnt(4)
    v_mfma_f32_32x32x16_bf16 v[128:143], a[4:7], a[104:107], v[128:143]
    ds_read_b64_tr_b16 a[96:97], v9 offset:38912
    ds_read_b64_tr_b16 a[98:99], v9 offset:39936
    ds_read_b64_tr_b16 a[100:101], v9 offset:39168
    ds_read_b64_tr_b16 a[102:103], v9 offset:40192
    v_mfma_f32_32x32x16_bf16 v[144:159], a[4:7], a[108:111], v[144:159]
    s_add_u32 s38, s38, 4096
    s_cmp_ge_u32 s38, s39
    s_cselect_b32 s38, s45, s38
    buffer_load_dwordx4 a[48:51], v15, s[20:23], s38 offen offset:0 sc1
    buffer_load_dwordx4 a[52:55], v15, s[20:23], s38 offen offset:1024 sc1
    s_waitcnt vmcnt(11) lgkmcnt(4)
    v_mfma_f32_32x32x16_bf16 v[128:143], a[8:11], a[112:115], v[128:143]
    ds_read_b64_tr_b16 a[104:105], v9 offset:40960
    ds_read_b64_tr_b16 a[106:107], v9 offset:41984
    ds_read_b64_tr_b16 a[108:109], v9 offset:41216
    ds_read_b64_tr_b16 a[110:111], v9 offset:42240
    v_mfma_f32_32x32x16_bf16 v[144:159], a[8:11], a[116:119], v[144:159]
    buffer_load_dwordx4 a[56:59], v15, s[20:23], s38 offen offset:2048 sc1
    buffer_load_dwordx4 a[60:63], v15, s[20:23], s38 offen offset:3072 sc1
    s_waitcnt vmcnt(12) lgkmcnt(4)
    v_mfma_f32_32x32x16_bf16 v[128:143], a[12:15], a[96:99], v[128:143]
    ds_read_b64_tr_b16 a[112:113], v9 offset:43008
    ds_read_b64_tr_b16 a[114:115], v9 offset:44032
    ds_read_b64_tr_b16 a[116:117], v9 offset:43264
    ds_read_b64_tr_b16 a[118:119], v9 offset:44288
    v_mfma_f32_32x32x16_bf16 v[144:159], a[12:15], a[100:103], v[144:159]
    s_add_u32 s38, s38, 4096
    s_cmp_ge_u32 s38, s39
    s_cselect_b32 s38, s45, s38
    buffer_load_dwordx4 a[64:67], v15, s[20:23], s38 offen offset:0 sc1
    buffer_load_dwordx4 a[68:71], v15, s[20:23], s38 offen offset:1024 sc1
    s_waitcnt vmcnt(13) lgkmcnt(4)
    v_mfma_f32_32x32x16_bf16 v[128:143], a[16:19], a[104:107], v[128:143]
    ds_read_b64_tr_b16 a[96:97], v9 offset:45056
    ds_read_b64_tr_b16 a[98:99], v9 offset:46080
    ds_read_b64_tr_b16 a[100:101], v9 offset:45312
    ds_read_b64_tr_b16 a[102:103], v9 offset:46336
    v_mfma_f32_32x32x16_bf16 v[144:159], a[16:19], a[108:111], v[144:159]
    buffer_load_dwordx4 a[72:75], v15, s[20:23], s38 offen offset:2048 sc1
    buffer_load_dwordx4 a[76:79], v15, s[20:23], s38 offen offset:3072 sc1
    s_waitcnt vmcnt(14) lgkmcnt(4)
    v_mfma_f32_32x32x16_bf16 v[128:143], a[20:23], a[112:115], v[128:143]
    ds_read_b64_tr_b16 a[104:105], v9 offset:47104
    ds_read_b64_tr_b16 a[106:107], v9 offset:48128
    ds_read_b64_tr_b16 a[108:109], v9 offset:47360
    ds_read_b64_tr_b16 a[110:111], v9 offset:48384
    v_mfma_f32_32x32x16_bf16 v[144:159], a[20:23], a[116:119], v[144:159]
    s_add_u32 s38, s38, 4096
    s_cmp_ge_u32 s38, s39
    s_cselect_b32 s38, s45, s38
    buffer_load_dwordx4 a[80:83], v15, s[20:23], s38 offen offset:0 sc1
    buffer_load_dwordx4 a[84:87], v15, s[20:23], s38 offen offset:1024 sc1
    s_waitcnt vmcnt(15) lgkmcnt(4)
    v_mfma_f32_32x32x16_bf16 v[128:143], a[24:27], a[96:99], v[128:143]
    ds_read_b64_tr_b16 a[112:113], v9 offset:49152
    ds_read_b64_tr_b16 a[114:115], v9 offset:50176
    ds_read_b64_tr_b16 a[116:117], v9 offset:49408
    ds_read_b64_tr_b16 a[118:119], v9 offset:50432
    v_mfma_f32_32x32x16_bf16 v[144:159], a[24:27], a[100:103], v[144:159]
    buffer_load_dwordx4 a[88:91], v15, s[20:23], s38 offen offset:2048 sc1
    buffer_load_dwordx4 a[92:95], v15, s[20:23], s38 offen offset:3072 sc1
    s_waitcnt vmcnt(16) lgkmcnt(4)
    v_mfma_f32_32x32x16_bf16 v[128:143], a[28:31], a[104:107], v[128:143]
    ds_read_b64_tr_b16 a[96:97], v9 offset:51200
    ds_read_b64_tr_b16 a[98:99], v9 offset:52224
    ds_read_b64_tr_b16 a[100:101], v9 offset:51456
    ds_read_b64_tr_b16 a[102:103], v9 offset:52480
    v_mfma_f32_32x32x16_bf16 v[144:159], a[28:31], a[108:111], v[144:159]
    s_add_u32 s38, s38, 4096
    s_cmp_ge_u32 s38, s39
    s_cselect_b32 s38, s45, s38
    buffer_load_dwordx4 a[0:3], v15, s[20:23], s38 offen offset:0 sc1
    buffer_load_dwordx4 a[4:7], v15, s[20:23], s38 offen offset:1024 sc1
    s_waitcnt vmcnt(17) lgkmcnt(4)
    v_mfma_f32_32x32x16_bf16 v[128:143], a[32:35], a[112:115], v[128:143]
    s_barrier
    ds_read_b64_tr_b16 a[104:105], v9 offset:53248
    ds_read_b64_tr_b16 a[106:107], v9 offset:54272
    ds_read_b64_tr_b16 a[108:109], v9 offset:53504
    ds_read_b64_tr_b16 a[110:111], v9 offset:54528
    v_mfma_f32_32x32x16_bf16 v[144:159], a[32:35], a[116:119], v[144:159]
    buffer_load_dwordx4 a[8:11], v15, s[20:23], s38 offen offset:2048 sc1
    buffer_load_dwordx4 a[12:15], v15, s[20:23], s38 offen offset:3072 sc1
    s_waitcnt vmcnt(18) lgkmcnt(4)
    v_mfma_f32_32x32x16_bf16 v[128:143], a[36:39], a[96:99], v[128:143]
    ds_read_b64_tr_b16 a[112:113], v9 offset:55296
    ds_read_b64_tr_b16 a[114:115], v9 offset:56320
    ds_read_b64_tr_b16 a[116:117], v9 offset:55552
    ds_read_b64_tr_b16 a[118:119], v9 offset:56576
    v_mfma_f32_32x32x16_bf16 v[144:159], a[36:39], a[100:103], v[144:159]
    s_add_u32 s38, s38, 4096
    s_cmp_ge_u32 s38, s39
    s_cselect_b32 s38, s45, s38
    buffer_load_dwordx4 a[16:19], v15, s[20:23], s38 offen offset:0 sc1
    buffer_load_dwordx4 a[20:23], v15, s[20:23], s38 offen offset:1024 sc1
    s_waitcnt vmcnt(19) lgkmcnt(4)
    v_mfma_f32_32x32x16_bf16 v[128:143], a[40:43], a[104:107], v[128:143]
    ds_read_b64_tr_b16 a[96:97], v9 offset:57344
    ds_read_b64_tr_b16 a[98:99], v9 offset:58368
    ds_read_b64_tr_b16 a[100:101], v9 offset:57600
    ds_read_b64_tr_b16 a[102:103], v9 offset:58624
    v_mfma_f32_32x32x16_bf16 v[144:159], a[40:43], a[108:111], v[144:159]
    buffer_load_dwordx4 a[24:27], v15, s[20:23], s38 offen offset:2048 sc1
    buffer_load_dwordx4 a[28:31], v15, s[20:23], s38 offen offset:3072 sc1
    s_waitcnt vmcnt(20) lgkmcnt(4)
    v_mfma_f32_32x32x16_bf16 v[128:143], a[44:47], a[112:115], v[128:143]
    ds_read_b64_tr_b16 a[104:105], v9 offset:59392
    ds_read_b64_tr_b16 a[106:107], v9 offset:60416
    ds_read_b64_tr_b16 a[108:109], v9 offset:59648
    ds_read_b64_tr_b16 a[110:111], v9 offset:60672
    v_mfma_f32_32x32x16_bf16 v[144:159], a[44:47], a[116:119], v[144:159]
    s_add_u32 s38, s38, 4096
    s_cmp_ge_u32 s38, s39
    s_cselect_b32 s38, s45, s38
    buffer_load_dwordx4 a[32:35], v15, s[20:23], s38 offen offset:0 sc1
    buffer_load_dwordx4 a[36:39], v15, s[20:23], s38 offen offset:1024 sc1
    s_waitcnt vmcnt(21) lgkmcnt(4)
    v_mfma_f32_32x32x16_bf16 v[128:143], a[48:51], a[96:99], v[128:143]
    ds_read_b64_tr_b16 a[112:113], v9 offset:61440
    ds_read_b64_tr_b16 a[114:115], v9 offset:62464
    ds_read_b64_tr_b16 a[116:117], v9 offset:61696
    ds_read_b64_tr_b16 a[118:119], v9 offset:62720
    v_mfma_f32_32x32x16_bf16 v[144:159], a[48:51], a[100:103], v[144:159]
    buffer_load_dwordx4 a[40:43], v15, s[20:23], s38 offen offset:2048 sc1
    buffer_load_dwordx4 a[44:47], v15, s[20:23], s38 offen offset:3072 sc1
    s_waitcnt vmcnt(22) lgkmcnt(4)
    v_mfma_f32_32x32x16_bf16 v[128:143], a[52:55], a[104:107], v[128:143]
    ds_read_b64_tr_b16 a[96:97], v9 offset:63488
    ds_read_b64_tr_b16 a[98:99], v9 offset:64512
    ds_read_b64_tr_b16 a[100:101], v9 offset:63744
    ds_read_b64_tr_b16 a[102:103], v9 offset:64768
    v_mfma_f32_32x32x16_bf16 v[144:159], a[52:55], a[108:111], v[144:159]
    s_add_u32 s38, s38, 4096
    s_cmp_ge_u32 s38, s39
    s_cselect_b32 s38, s45, s38
    buffer_load_dwordx4 a[48:51], v15, s[20:23], s38 offen offset:0 sc1
    buffer_load_dwordx4 a[52:55], v15, s[20:23], s38 offen offset:1024 sc1
    s_waitcnt vmcnt(23) lgkmcnt(4)
    v_mfma_f32_32x32x16_bf16 v[128:143], a[56:59], a[112:115], v[128:143]
    ds_read_b64_tr_b16 a[104:105], v10 offset:0
    ds_read_b64_tr_b16 a[106:107], v10 offset:1024
    ds_read_b64_tr_b16 a[108:109], v10 offset:256
    ds_read_b64_tr_b16 a[110:111], v10 offset:1280
    v_mfma_f32_32x32x16_bf16 v[144:159], a[56:59], a[116:119], v[144:159]
    buffer_load_dwordx4 a[56:59], v15, s[20:23], s38 offen offset:2048 sc1
    s_waitcnt vmcnt(23) lgkmcnt(4)
    v_mfma_f32_32x32x16_bf16 v[128:143], a[60:63], a[96:99], v[128:143]
    ds_read_b64_tr_b16 a[112:113], v10 offset:2048
    ds_read_b64_tr_b16 a[114:115], v10 offset:3072
    ds_read_b64_tr_b16 a[116:117], v10 offset:2304
    ds_read_b64_tr_b16 a[118:119], v10 offset:3328
    v_mfma_f32_32x32x16_bf16 v[144:159], a[60:63], a[100:103], v[144:159]
    buffer_load_dwordx4 a[60:63], v15, s[20:23], s38 offen offset:3072 sc1
    s_waitcnt vmcnt(23) lgkmcnt(4)
    v_mfma_f32_32x32x16_bf16 v[128:143], a[64:67], a[104:107], v[128:143]
    ds_read_b64_tr_b16 a[96:97], v10 offset:4096
    ds_read_b64_tr_b16 a[98:99], v10 offset:5120
    ds_read_b64_tr_b16 a[100:101], v10 offset:4352
    ds_read_b64_tr_b16 a[102:103], v10 offset:5376
    v_mfma_f32_32x32x16_bf16 v[144:159], a[64:67], a[108:111], v[144:159]
    s_add_u32 s38, s38, 4096
    s_cmp_ge_u32 s38, s39
    s_cselect_b32 s38, s45, s38
    buffer_load_dwordx4 a[64:67], v15, s[20:23], s38 offen offset:0 sc1
    s_waitcnt vmcnt(23) lgkmcnt(4)
    v_mfma_f32_32x32x16_bf16 v[128:143], a[68:71], a[112:115], v[128:143]
    ds_read_b64_tr_b16 a[104:105], v10 offset:6144
    ds_read_b64_tr_b16 a[106:107], v10 offset:7168
    ds_read_b64_tr_b16 a[108:109], v10 offset:6400
    ds_read_b64_tr_b16 a[110:111], v10 offset:7424
    v_mfma_f32_32x32x16_bf16 v[144:159], a[68:71], a[116:119], v[144:159]
    buffer_load_dwordx4 a[68:71], v15, s[20:23], s38 offen offset:1024 sc1
    s_waitcnt vmcnt(23) lgkmcnt(4)
    v_mfma_f32_32x32x16_bf16 v[128:143], a[72:75], a[96:99], v[128:143]
    ds_read_b64_tr_b16 a[112:113], v10 offset:8192
    ds_read_b64_tr_b16 a[114:115], v10 offset:9216
    ds_read_b64_tr_b16 a[116:117], v10 offset:8448
    ds_read_b64_tr_b16 a[118:119], v10 offset:9472
    v_mfma_f32_32x32x16_bf16 v[144:159], a[72:75], a[100:103], v[144:159]
    buffer_load_dwordx4 a[72:75], v15, s[20:23], s38 offen offset:2048 sc1
    v_readlane_b32 s40, v14, 40
    v_readlane_b32 s41, v14, 41
    s_add_u32 m0, s96, 98304
    s_nop 2
    v_readlane_b32 s42, v14, 42
    buffer_load_dwordx4 v13, s[72:75], s40 offen  lds
    s_waitcnt vmcnt(24) lgkmcnt(4)
    v_mfma_f32_32x32x16_bf16 v[128:143], a[76:79], a[104:107], v[128:143]
    ds_read_b64_tr_b16 a[96:97], v10 offset:10240
    ds_read_b64_tr_b16 a[98:99], v10 offset:11264
    ds_read_b64_tr_b16 a[100:101], v10 offset:10496
    ds_read_b64_tr_b16 a[102:103], v10 offset:11520
    v_mfma_f32_32x32x16_bf16 v[144:159], a[76:79], a[108:111], v[144:159]
    buffer_load_dwordx4 a[76:79], v15, s[20:23], s38 offen offset:3072 sc1
    s_waitcnt vmcnt(24) lgkmcnt(4)
    v_mfma_f32_32x32x16_bf16 v[128:143], a[80:83], a[112:115], v[128:143]
    ds_read_b64_tr_b16 a[104:105], v10 offset:12288
    ds_read_b64_tr_b16 a[106:107], v10 offset:13312
    ds_read_b64_tr_b16 a[108:109], v10 offset:12544
    ds_read_b64_tr_b16 a[110:111], v10 offset:13568
    v_mfma_f32_32x32x16_bf16 v[144:159], a[80:83], a[116:119], v[144:159]
    s_add_u32 s38, s38, 4096
    s_cmp_ge_u32 s38, s39
    s_cselect_b32 s38, s45, s38
    buffer_load_dwordx4 a[80:83], v15, s[20:23], s38 offen offset:0 sc1
    s_waitcnt vmcnt(24) lgkmcnt(4)
    v_mfma_f32_32x32x16_bf16 v[128:143], a[84:87], a[96:99], v[128:143]
    ds_read_b64_tr_b16 a[112:113], v10 offset:14336
    ds_read_b64_tr_b16 a[114:115], v10 offset:15360
    ds_read_b64_tr_b16 a[116:117], v10 offset:14592
    ds_read_b64_tr_b16 a[118:119], v10 offset:15616
    v_mfma_f32_32x32x16_bf16 v[144:159], a[84:87], a[100:103], v[144:159]
    buffer_load_dwordx4 a[84:87], v15, s[20:23], s38 offen offset:1024 sc1
    s_waitcnt vmcnt(24) lgkmcnt(4)
    v_mfma_f32_32x32x16_bf16 v[128:143], a[88:91], a[104:107], v[128:143]
    ds_read_b64_tr_b16 a[96:97], v8 offset:0
    ds_read_b64_tr_b16 a[98:99], v8 offset:1024
    ds_read_b64_tr_b16 a[100:101], v8 offset:256
    ds_read_b64_tr_b16 a[102:103], v8 offset:1280
    v_mfma_f32_32x32x16_bf16 v[144:159], a[88:91], a[108:111], v[144:159]
    buffer_load_dwordx4 a[88:91], v15, s[20:23], s38 offen offset:2048 sc1
    s_add_u32 m0, s96, 102400
    s_nop 0
    buffer_load_dwordx4 v13, s[76:79], s41 offen  lds
    s_waitcnt vmcnt(25) lgkmcnt(4)
    v_mfma_f32_32x32x16_bf16 v[128:143], a[92:95], a[112:115], v[128:143]
    ds_read_b64_tr_b16 a[104:105], v8 offset:2048
    ds_read_b64_tr_b16 a[106:107], v8 offset:3072
    ds_read_b64_tr_b16 a[108:109], v8 offset:2304
    ds_read_b64_tr_b16 a[110:111], v8 offset:3328
    v_mfma_f32_32x32x16_bf16 v[144:159], a[92:95], a[116:119], v[144:159]
    buffer_load_dwordx4 a[92:95], v15, s[20:23], s38 offen offset:3072 sc1
    s_waitcnt vmcnt(25) lgkmcnt(4)
    v_mfma_f32_32x32x16_bf16 v[128:143], a[0:3], a[96:99], v[128:143]
    ds_read_b64_tr_b16 a[112:113], v8 offset:4096
    ds_read_b64_tr_b16 a[114:115], v8 offset:5120
    ds_read_b64_tr_b16 a[116:117], v8 offset:4352
    ds_read_b64_tr_b16 a[118:119], v8 offset:5376
    v_mfma_f32_32x32x16_bf16 v[144:159], a[0:3], a[100:103], v[144:159]
    s_add_u32 s38, s38, 4096
    s_cmp_ge_u32 s38, s39
    s_cselect_b32 s38, s45, s38
    buffer_load_dwordx4 a[0:3], v15, s[20:23], s38 offen offset:0 sc1
    s_waitcnt vmcnt(25) lgkmcnt(4)
    v_mfma_f32_32x32x16_bf16 v[128:143], a[4:7], a[104:107], v[128:143]
    ds_read_b64_tr_b16 a[96:97], v8 offset:6144
    ds_read_b64_tr_b16 a[98:99], v8 offset:7168
    ds_read_b64_tr_b16 a[100:101], v8 offset:6400
    ds_read_b64_tr_b16 a[102:103], v8 offset:7424
    v_mfma_f32_32x32x16_bf16 v[144:159], a[4:7], a[108:111], v[144:159]
    buffer_load_dwordx4 a[4:7], v15, s[20:23], s38 offen offset:1024 sc1
    s_waitcnt vmcnt(25) lgkmcnt(4)
    v_mfma_f32_32x32x16_bf16 v[128:143], a[8:11], a[112:115], v[128:143]
    ds_read_b64_tr_b16 a[104:105], v8 offset:8192
    ds_read_b64_tr_b16 a[106:107], v8 offset:9216
    ds_read_b64_tr_b16 a[108:109], v8 offset:8448
    ds_read_b64_tr_b16 a[110:111], v8 offset:9472
    v_mfma_f32_32x32x16_bf16 v[144:159], a[8:11], a[116:119], v[144:159]
    buffer_load_dwordx4 a[8:11], v15, s[20:23], s38 offen offset:2048 sc1
    s_add_u32 m0, s96, 106496
    s_nop 0
    buffer_load_dwordx4 v13, s[72:75], s42 offen  lds
    s_waitcnt vmcnt(26) lgkmcnt(4)
    v_mfma_f32_32x32x16_bf16 v[128:143], a[12:15], a[96:99], v[128:143]
    ds_read_b64_tr_b16 a[112:113], v8 offset:10240
    ds_read_b64_tr_b16 a[114:115], v8 offset:11264
    ds_read_b64_tr_b16 a[116:117], v8 offset:10496
    ds_read_b64_tr_b16 a[118:119], v8 offset:11520
    v_mfma_f32_32x32x16_bf16 v[144:159], a[12:15], a[100:103], v[144:159]
    buffer_load_dwordx4 a[12:15], v15, s[20:23], s38 offen offset:3072 sc1
    s_waitcnt vmcnt(26) lgkmcnt(4)
    v_mfma_f32_32x32x16_bf16 v[128:143], a[16:19], a[104:107], v[128:143]
    ds_read_b64_tr_b16 a[96:97], v8 offset:12288
    ds_read_b64_tr_b16 a[98:99], v8 offset:13312
    ds_read_b64_tr_b16 a[100:101], v8 offset:12544
    ds_read_b64_tr_b16 a[102:103], v8 offset:13568
    v_mfma_f32_32x32x16_bf16 v[144:159], a[16:19], a[108:111], v[144:159]
    s_add_u32 s38, s38, 4096
    s_cmp_ge_u32 s38, s39
    s_cselect_b32 s38, s45, s38
    buffer_load_dwordx4 a[16:19], v15, s[20:23], s38 offen offset:0 sc1
    s_waitcnt vmcnt(26) lgkmcnt(4)
    v_mfma_f32_32x32x16_bf16 v[128:143], a[20:23], a[112:115], v[128:143]
    ds_read_b64_tr_b16 a[104:105], v8 offset:14336
    ds_read_b64_tr_b16 a[106:107], v8 offset:15360
    ds_read_b64_tr_b16 a[108:109], v8 offset:14592
    ds_read_b64_tr_b16 a[110:111], v8 offset:15616
    v_mfma_f32_32x32x16_bf16 v[144:159], a[20:23], a[116:119], v[144:159]
    buffer_load_dwordx4 a[20:23], v15, s[20:23], s38 offen offset:1024 sc1
    s_waitcnt vmcnt(26) lgkmcnt(4)
    v_mfma_f32_32x32x16_bf16 v[128:143], a[24:27], a[96:99], v[128:143]
    ds_read_b64_tr_b16 a[112:113], v8 offset:16384
    ds_read_b64_tr_b16 a[114:115], v8 offset:17408
    ds_read_b64_tr_b16 a[116:117], v8 offset:16640
    ds_read_b64_tr_b16 a[118:119], v8 offset:17664
    v_mfma_f32_32x32x16_bf16 v[144:159], a[24:27], a[100:103], v[144:159]
    buffer_load_dwordx4 a[24:27], v15, s[20:23], s38 offen offset:2048 sc1
    s_add_u32 s35, s34, 4096
    s_waitcnt vmcnt(26) lgkmcnt(4)
    v_mfma_f32_32x32x16_bf16 v[128:143], a[28:31], a[104:107], v[128:143]
    ds_read_b64_tr_b16 a[96:97], v8 offset:18432
    ds_read_b64_tr_b16 a[98:99], v8 offset:19456
    ds_read_b64_tr_b16 a[100:101], v8 offset:18688
    ds_read_b64_tr_b16 a[102:103], v8 offset:19712
    v_mfma_f32_32x32x16_bf16 v[144:159], a[28:31], a[108:111], v[144:159]
    buffer_load_dwordx4 a[28:31], v15, s[20:23], s38 offen offset:3072 sc1
    s_waitcnt vmcnt(26) lgkmcnt(4)
    v_mfma_f32_32x32x16_bf16 v[128:143], a[32:35], a[112:115], v[128:143]
    ds_read_b64_tr_b16 a[104:105], v8 offset:20480
    ds_read_b64_tr_b16 a[106:107], v8 offset:21504
    ds_read_b64_tr_b16 a[108:109], v8 offset:20736
    ds_read_b64_tr_b16 a[110:111], v8 offset:21760
    v_mfma_f32_32x32x16_bf16 v[144:159], a[32:35], a[116:119], v[144:159]
    s_add_u32 s38, s38, 4096
    s_cmp_ge_u32 s38, s39
    s_cselect_b32 s38, s45, s38
    buffer_load_dwordx4 a[32:35], v15, s[20:23], s38 offen offset:0 sc1
    s_waitcnt vmcnt(26) lgkmcnt(4)
    v_mfma_f32_32x32x16_bf16 v[128:143], a[36:39], a[96:99], v[128:143]
    ds_read_b64_tr_b16 a[112:113], v8 offset:22528
    ds_read_b64_tr_b16 a[114:115], v8 offset:23552
    ds_read_b64_tr_b16 a[116:117], v8 offset:22784
    ds_read_b64_tr_b16 a[118:119], v8 offset:23808
    v_mfma_f32_32x32x16_bf16 v[144:159], a[36:39], a[100:103], v[144:159]
    buffer_load_dwordx4 a[36:39], v15, s[20:23], s38 offen offset:1024 sc1
    s_waitcnt vmcnt(26) lgkmcnt(4)
    v_mfma_f32_32x32x16_bf16 v[128:143], a[40:43], a[104:107], v[128:143]
    ds_read_b64_tr_b16 a[96:97], v8 offset:24576
    ds_read_b64_tr_b16 a[98:99], v8 offset:25600
    ds_read_b64_tr_b16 a[100:101], v8 offset:24832
    ds_read_b64_tr_b16 a[102:103], v8 offset:25856
    v_mfma_f32_32x32x16_bf16 v[144:159], a[40:43], a[108:111], v[144:159]
    buffer_load_dwordx4 a[40:43], v15, s[20:23], s38 offen offset:2048 sc1
    s_waitcnt vmcnt(26) lgkmcnt(4)
    v_mfma_f32_32x32x16_bf16 v[128:143], a[44:47], a[112:115], v[128:143]
    ds_read_b64_tr_b16 a[104:105], v8 offset:26624
    ds_read_b64_tr_b16 a[106:107], v8 offset:27648
    ds_read_b64_tr_b16 a[108:109], v8 offset:26880
    ds_read_b64_tr_b16 a[110:111], v8 offset:27904
    v_mfma_f32_32x32x16_bf16 v[144:159], a[44:47], a[116:119], v[144:159]
    buffer_load_dwordx4 a[44:47], v15, s[20:23], s38 offen offset:3072 sc1
    s_waitcnt vmcnt(26) lgkmcnt(4)
    v_mfma_f32_32x32x16_bf16 v[128:143], a[48:51], a[96:99], v[128:143]
    ds_read_b64_tr_b16 a[112:113], v8 offset:28672
    ds_read_b64_tr_b16 a[114:115], v8 offset:29696
    ds_read_b64_tr_b16 a[116:117], v8 offset:28928
    ds_read_b64_tr_b16 a[118:119], v8 offset:29952
    v_mfma_f32_32x32x16_bf16 v[144:159], a[48:51], a[100:103], v[144:159]
    s_add_u32 s38, s38, 4096
    s_cmp_ge_u32 s38, s39
    s_cselect_b32 s38, s45, s38
    buffer_load_dwordx4 a[48:51], v15, s[20:23], s38 offen offset:0 sc1
    s_waitcnt vmcnt(26) lgkmcnt(4)
    v_mfma_f32_32x32x16_bf16 v[128:143], a[52:55], a[104:107], v[128:143]
    ds_read_b64_tr_b16 a[96:97], v8 offset:30720
    ds_read_b64_tr_b16 a[98:99], v8 offset:31744
    ds_read_b64_tr_b16 a[100:101], v8 offset:30976
    ds_read_b64_tr_b16 a[102:103], v8 offset:32000
    v_mfma_f32_32x32x16_bf16 v[144:159], a[52:55], a[108:111], v[144:159]
    buffer_load_dwordx4 a[52:55], v15, s[20:23], s38 offen offset:1024 sc1
    s_waitcnt vmcnt(26) lgkmcnt(4)
    v_mfma_f32_32x32x16_bf16 v[128:143], a[56:59], a[112:115], v[128:143]
    ds_read_b64_tr_b16 a[104:105], v8 offset:32768
    ds_read_b64_tr_b16 a[106:107], v8 offset:33792
    ds_read_b64_tr_b16 a[108:109], v8 offset:33024
    ds_read_b64_tr_b16 a[110:111], v8 offset:34048
    v_mfma_f32_32x32x16_bf16 v[144:159], a[56:59], a[116:119], v[144:159]
    buffer_load_dwordx4 a[56:59], v15, s[20:23], s38 offen offset:2048 sc1
    s_waitcnt vmcnt(26) lgkmcnt(4)
    v_mfma_f32_32x32x16_bf16 v[128:143], a[60:63], a[96:99], v[128:143]
    ds_read_b64_tr_b16 a[112:113], v8 offset:34816
    ds_read_b64_tr_b16 a[114:115], v8 offset:35840
    ds_read_b64_tr_b16 a[116:117], v8 offset:35072
    ds_read_b64_tr_b16 a[118:119], v8 offset:36096
    v_mfma_f32_32x32x16_bf16 v[144:159], a[60:63], a[100:103], v[144:159]
    buffer_load_dwordx4 a[60:63], v15, s[20:23], s38 offen offset:3072 sc1
    s_waitcnt vmcnt(26) lgkmcnt(4)
    v_mfma_f32_32x32x16_bf16 v[128:143], a[64:67], a[104:107], v[128:143]
    ds_read_b64_tr_b16 a[96:97], v8 offset:36864
    ds_read_b64_tr_b16 a[98:99], v8 offset:37888
    ds_read_b64_tr_b16 a[100:101], v8 offset:37120
    ds_read_b64_tr_b16 a[102:103], v8 offset:38144
    v_mfma_f32_32x32x16_bf16 v[144:159], a[64:67], a[108:111], v[144:159]
    s_add_u32 s38, s38, 4096
    s_cmp_ge_u32 s38, s39
    s_cselect_b32 s38, s45, s38
    buffer_load_dwordx4 a[64:67], v15, s[20:23], s38 offen offset:0 sc1
    s_waitcnt vmcnt(26) lgkmcnt(4)
    v_mfma_f32_32x32x16_bf16 v[128:143], a[68:71], a[112:115], v[128:143]
    ds_read_b64_tr_b16 a[104:105], v8 offset:38912
    ds_read_b64_tr_b16 a[106:107], v8 offset:39936
    ds_read_b64_tr_b16 a[108:109], v8 offset:39168
    ds_read_b64_tr_b16 a[110:111], v8 offset:40192
    v_mfma_f32_32x32x16_bf16 v[144:159], a[68:71], a[116:119], v[144:159]
    buffer_load_dwordx4 a[68:71], v15, s[20:23], s38 offen offset:1024 sc1
    s_waitcnt vmcnt(26) lgkmcnt(4)
    v_mfma_f32_32x32x16_bf16 v[128:143], a[72:75], a[96:99], v[128:143]
    ds_read_b64_tr_b16 a[112:113], v8 offset:40960
    ds_read_b64_tr_b16 a[114:115], v8 offset:41984
    ds_read_b64_tr_b16 a[116:117], v8 offset:41216
    ds_read_b64_tr_b16 a[118:119], v8 offset:42240
    v_mfma_f32_32x32x16_bf16 v[144:159], a[72:75], a[100:103], v[144:159]
    buffer_load_dwordx4 a[72:75], v15, s[20:23], s38 offen offset:2048 sc1
    s_waitcnt vmcnt(25) lgkmcnt(4)
    v_mfma_f32_32x32x16_bf16 v[128:143], a[76:79], a[104:107], v[128:143]
    ds_read_b64_tr_b16 a[96:97], v8 offset:43008
    ds_read_b64_tr_b16 a[98:99], v8 offset:44032
    ds_read_b64_tr_b16 a[100:101], v8 offset:43264
    ds_read_b64_tr_b16 a[102:103], v8 offset:44288
    v_mfma_f32_32x32x16_bf16 v[144:159], a[76:79], a[108:111], v[144:159]
    buffer_load_dwordx4 a[76:79], v15, s[20:23], s38 offen offset:3072 sc1
    s_waitcnt vmcnt(25) lgkmcnt(4)
    v_mfma_f32_32x32x16_bf16 v[128:143], a[80:83], a[112:115], v[128:143]
    ds_read_b64_tr_b16 a[104:105], v8 offset:45056
    ds_read_b64_tr_b16 a[106:107], v8 offset:46080
    ds_read_b64_tr_b16 a[108:109], v8 offset:45312
    ds_read_b64_tr_b16 a[110:111], v8 offset:46336
    v_mfma_f32_32x32x16_bf16 v[144:159], a[80:83], a[116:119], v[144:159]
    s_add_u32 s38, s38, 4096
    s_cmp_ge_u32 s38, s39
    s_cselect_b32 s38, s45, s38
    buffer_load_dwordx4 a[80:83], v15, s[20:23], s38 offen offset:0 sc1
    s_waitcnt vmcnt(25) lgkmcnt(4)
    v_mfma_f32_32x32x16_bf16 v[128:143], a[84:87], a[96:99], v[128:143]
    ds_read_b64_tr_b16 a[112:113], v8 offset:47104
    ds_read_b64_tr_b16 a[114:115], v8 offset:48128
    ds_read_b64_tr_b16 a[116:117], v8 offset:47360
    ds_read_b64_tr_b16 a[118:119], v8 offset:48384
    v_mfma_f32_32x32x16_bf16 v[144:159], a[84:87], a[100:103], v[144:159]
    buffer_load_dwordx4 a[84:87], v15, s[20:23], s38 offen offset:1024 sc1
    s_waitcnt vmcnt(25) lgkmcnt(4)
    v_mfma_f32_32x32x16_bf16 v[128:143], a[88:91], a[104:107], v[128:143]
    ds_read_b64_tr_b16 a[96:97], v8 offset:49152
    ds_read_b64_tr_b16 a[98:99], v8 offset:50176
    ds_read_b64_tr_b16 a[100:101], v8 offset:49408
    ds_read_b64_tr_b16 a[102:103], v8 offset:50432
    v_mfma_f32_32x32x16_bf16 v[144:159], a[88:91], a[108:111], v[144:159]
    buffer_load_dwordx4 a[88:91], v15, s[20:23], s38 offen offset:2048 sc1
    s_waitcnt vmcnt(24) lgkmcnt(4)
    v_mfma_f32_32x32x16_bf16 v[128:143], a[92:95], a[112:115], v[128:143]
    ds_read_b64_tr_b16 a[104:105], v8 offset:51200
    ds_read_b64_tr_b16 a[106:107], v8 offset:52224
    ds_read_b64_tr_b16 a[108:109], v8 offset:51456
    ds_read_b64_tr_b16 a[110:111], v8 offset:52480
    v_mfma_f32_32x32x16_bf16 v[144:159], a[92:95], a[116:119], v[144:159]
    buffer_load_dwordx4 a[92:95], v15, s[20:23], s38 offen offset:3072 sc1
    s_waitcnt vmcnt(24) lgkmcnt(4)
    v_mfma_f32_32x32x16_bf16 v[128:143], a[0:3], a[96:99], v[128:143]
    ds_read_b64_tr_b16 a[112:113], v8 offset:53248
    ds_read_b64_tr_b16 a[114:115], v8 offset:54272
    ds_read_b64_tr_b16 a[116:117], v8 offset:53504
    ds_read_b64_tr_b16 a[118:119], v8 offset:54528
    v_mfma_f32_32x32x16_bf16 v[144:159], a[0:3], a[100:103], v[144:159]
    s_add_u32 s38, s38, 4096
    s_cmp_ge_u32 s38, s39
    s_cselect_b32 s38, s45, s38
    buffer_load_dwordx4 a[0:3], v15, s[20:23], s38 offen offset:0 sc1
    s_waitcnt vmcnt(24) lgkmcnt(4)
    v_mfma_f32_32x32x16_bf16 v[128:143], a[4:7], a[104:107], v[128:143]
    ds_read_b64_tr_b16 a[96:97], v8 offset:55296
    ds_read_b64_tr_b16 a[98:99], v8 offset:56320
    ds_read_b64_tr_b16 a[100:101], v8 offset:55552
    ds_read_b64_tr_b16 a[102:103], v8 offset:56576
    v_mfma_f32_32x32x16_bf16 v[144:159], a[4:7], a[108:111], v[144:159]
    buffer_load_dwordx4 a[4:7], v15, s[20:23], s38 offen offset:1024 sc1
    s_waitcnt vmcnt(24) lgkmcnt(4)
    v_mfma_f32_32x32x16_bf16 v[128:143], a[8:11], a[112:115], v[128:143]
    ds_read_b64_tr_b16 a[104:105], v8 offset:57344
    ds_read_b64_tr_b16 a[106:107], v8 offset:58368
    ds_read_b64_tr_b16 a[108:109], v8 offset:57600
    ds_read_b64_tr_b16 a[110:111], v8 offset:58624
    v_mfma_f32_32x32x16_bf16 v[144:159], a[8:11], a[116:119], v[144:159]
    buffer_load_dwordx4 a[8:11], v15, s[20:23], s38 offen offset:2048 sc1
    s_waitcnt vmcnt(23) lgkmcnt(4)
    v_mfma_f32_32x32x16_bf16 v[128:143], a[12:15], a[96:99], v[128:143]
    ds_read_b64_tr_b16 a[112:113], v8 offset:59392
    ds_read_b64_tr_b16 a[114:115], v8 offset:60416
    ds_read_b64_tr_b16 a[116:117], v8 offset:59648
    ds_read_b64_tr_b16 a[118:119], v8 offset:60672
    v_mfma_f32_32x32x16_bf16 v[144:159], a[12:15], a[100:103], v[144:159]
    buffer_load_dwordx4 a[12:15], v15, s[20:23], s38 offen offset:3072 sc1
    s_waitcnt vmcnt(23) lgkmcnt(4)
    v_mfma_f32_32x32x16_bf16 v[128:143], a[16:19], a[104:107], v[128:143]
    ds_read_b64_tr_b16 a[96:97], v8 offset:61440
    ds_read_b64_tr_b16 a[98:99], v8 offset:62464
    ds_read_b64_tr_b16 a[100:101], v8 offset:61696
    ds_read_b64_tr_b16 a[102:103], v8 offset:62720
    v_mfma_f32_32x32x16_bf16 v[144:159], a[16:19], a[108:111], v[144:159]
    s_add_u32 s38, s38, 4096
    s_cmp_ge_u32 s38, s39
    s_cselect_b32 s38, s45, s38
    buffer_load_dwordx4 a[16:19], v15, s[20:23], s38 offen offset:0 sc1
    s_waitcnt vmcnt(23) lgkmcnt(4)
    v_mfma_f32_32x32x16_bf16 v[128:143], a[20:23], a[112:115], v[128:143]
    ds_read_b64_tr_b16 a[104:105], v8 offset:63488
    ds_read_b64_tr_b16 a[106:107], v8 offset:64512
    ds_read_b64_tr_b16 a[108:109], v8 offset:63744
    ds_read_b64_tr_b16 a[110:111], v8 offset:64768
    v_mfma_f32_32x32x16_bf16 v[144:159], a[20:23], a[116:119], v[144:159]
    buffer_load_dwordx4 a[20:23], v15, s[20:23], s38 offen offset:1024 sc1
    s_waitcnt vmcnt(23) lgkmcnt(4)
    v_mfma_f32_32x32x16_bf16 v[128:143], a[24:27], a[96:99], v[128:143]
    ds_read_b64_tr_b16 a[112:113], v9 offset:0
    ds_read_b64_tr_b16 a[114:115], v9 offset:1024
    ds_read_b64_tr_b16 a[116:117], v9 offset:256
    ds_read_b64_tr_b16 a[118:119], v9 offset:1280
    v_mfma_f32_32x32x16_bf16 v[144:159], a[24:27], a[100:103], v[144:159]
    buffer_load_dwordx4 a[24:27], v15, s[20:23], s38 offen offset:2048 sc1
    s_waitcnt vmcnt(23) lgkmcnt(4)
    v_mfma_f32_32x32x16_bf16 v[128:143], a[28:31], a[104:107], v[128:143]
    ds_read_b64_tr_b16 a[96:97], v9 offset:2048
    ds_read_b64_tr_b16 a[98:99], v9 offset:3072
    ds_read_b64_tr_b16 a[100:101], v9 offset:2304
    ds_read_b64_tr_b16 a[102:103], v9 offset:3328
    v_mfma_f32_32x32x16_bf16 v[144:159], a[28:31], a[108:111], v[144:159]
    buffer_load_dwordx4 a[28:31], v15, s[20:23], s38 offen offset:3072 sc1
    s_waitcnt vmcnt(23) lgkmcnt(4)
    v_mfma_f32_32x32x16_bf16 v[128:143], a[32:35], a[112:115], v[128:143]
    ds_read_b64_tr_b16 a[104:105], v9 offset:4096
    ds_read_b64_tr_b16 a[106:107], v9 offset:5120
    ds_read_b64_tr_b16 a[108:109], v9 offset:4352
    ds_read_b64_tr_b16 a[110:111], v9 offset:5376
    v_mfma_f32_32x32x16_bf16 v[144:159], a[32:35], a[116:119], v[144:159]
    s_add_u32 s38, s38, 4096
    s_cmp_ge_u32 s38, s39
    s_cselect_b32 s38, s45, s38
    buffer_load_dwordx4 a[32:35], v15, s[20:23], s38 offen offset:0 sc1
    s_waitcnt vmcnt(23) lgkmcnt(4)
    v_mfma_f32_32x32x16_bf16 v[128:143], a[36:39], a[96:99], v[128:143]
    ds_read_b64_tr_b16 a[112:113], v9 offset:6144
    ds_read_b64_tr_b16 a[114:115], v9 offset:7168
    ds_read_b64_tr_b16 a[116:117], v9 offset:6400
    ds_read_b64_tr_b16 a[118:119], v9 offset:7424
    v_mfma_f32_32x32x16_bf16 v[144:159], a[36:39], a[100:103], v[144:159]
    buffer_load_dwordx4 a[36:39], v15, s[20:23], s38 offen offset:1024 sc1
    s_waitcnt vmcnt(23) lgkmcnt(4)
    v_mfma_f32_32x32x16_bf16 v[128:143], a[40:43], a[104:107], v[128:143]
    ds_read_b64_tr_b16 a[96:97], v9 offset:8192
    ds_read_b64_tr_b16 a[98:99], v9 offset:9216
    ds_read_b64_tr_b16 a[100:101], v9 offset:8448
    ds_read_b64_tr_b16 a[102:103], v9 offset:9472
    v_mfma_f32_32x32x16_bf16 v[144:159], a[40:43], a[108:111], v[144:159]
    buffer_load_dwordx4 a[40:43], v15, s[20:23], s38 offen offset:2048 sc1
    s_waitcnt vmcnt(23) lgkmcnt(4)
    v_mfma_f32_32x32x16_bf16 v[128:143], a[44:47], a[112:115], v[128:143]
    ds_read_b64_tr_b16 a[104:105], v9 offset:10240
    ds_read_b64_tr_b16 a[106:107], v9 offset:11264
    ds_read_b64_tr_b16 a[108:109], v9 offset:10496
    ds_read_b64_tr_b16 a[110:111], v9 offset:11520
    v_mfma_f32_32x32x16_bf16 v[144:159], a[44:47], a[116:119], v[144:159]
    buffer_load_dwordx4 a[44:47], v15, s[20:23], s38 offen offset:3072 sc1
    s_waitcnt vmcnt(23) lgkmcnt(4)
    v_mfma_f32_32x32x16_bf16 v[128:143], a[48:51], a[96:99], v[128:143]
    ds_read_b64_tr_b16 a[112:113], v9 offset:12288
    ds_read_b64_tr_b16 a[114:115], v9 offset:13312
    ds_read_b64_tr_b16 a[116:117], v9 offset:12544
    ds_read_b64_tr_b16 a[118:119], v9 offset:13568
    v_mfma_f32_32x32x16_bf16 v[144:159], a[48:51], a[100:103], v[144:159]
    s_mov_b32 s38, s39
    buffer_load_dwordx4 a[48:51], v15, s[20:23], s38 offen offset:0 sc1
    s_waitcnt vmcnt(23) lgkmcnt(4)
    v_mfma_f32_32x32x16_bf16 v[128:143], a[52:55], a[104:107], v[128:143]
    ds_read_b64_tr_b16 a[96:97], v9 offset:14336
    ds_read_b64_tr_b16 a[98:99], v9 offset:15360
    ds_read_b64_tr_b16 a[100:101], v9 offset:14592
    ds_read_b64_tr_b16 a[102:103], v9 offset:15616
    v_mfma_f32_32x32x16_bf16 v[144:159], a[52:55], a[108:111], v[144:159]
    buffer_load_dwordx4 a[52:55], v15, s[20:23], s38 offen offset:1024 sc1
    s_waitcnt vmcnt(23) lgkmcnt(4)
    v_mfma_f32_32x32x16_bf16 v[128:143], a[56:59], a[112:115], v[128:143]
    ds_read_b64_tr_b16 a[104:105], v10 offset:20480
    ds_read_b64_tr_b16 a[106:107], v10 offset:21504
    ds_read_b64_tr_b16 a[108:109], v10 offset:20736
    ds_read_b64_tr_b16 a[110:111], v10 offset:21760
    v_mfma_f32_32x32x16_bf16 v[144:159], a[56:59], a[116:119], v[144:159]
    s_waitcnt vmcnt(22) lgkmcnt(4)
    v_mfma_f32_32x32x16_bf16 v[128:143], a[60:63], a[96:99], v[128:143]
    ds_read_b64_tr_b16 a[112:113], v10 offset:22528
    ds_read_b64_tr_b16 a[114:115], v10 offset:23552
    ds_read_b64_tr_b16 a[116:117], v10 offset:22784
    ds_read_b64_tr_b16 a[118:119], v10 offset:23808
    v_mfma_f32_32x32x16_bf16 v[144:159], a[60:63], a[100:103], v[144:159]
    s_waitcnt vmcnt(21) lgkmcnt(4)
    v_mfma_f32_32x32x16_bf16 v[128:143], a[64:67], a[104:107], v[128:143]
    ds_read_b64_tr_b16 a[96:97], v10 offset:24576
    ds_read_b64_tr_b16 a[98:99], v10 offset:25600
    ds_read_b64_tr_b16 a[100:101], v10 offset:24832
    ds_read_b64_tr_b16 a[102:103], v10 offset:25856
    v_mfma_f32_32x32x16_bf16 v[144:159], a[64:67], a[108:111], v[144:159]
    s_waitcnt vmcnt(20) lgkmcnt(4)
    v_mfma_f32_32x32x16_bf16 v[128:143], a[68:71], a[112:115], v[128:143]
    ds_read_b64_tr_b16 a[104:105], v10 offset:26624
    ds_read_b64_tr_b16 a[106:107], v10 offset:27648
    ds_read_b64_tr_b16 a[108:109], v10 offset:26880
    ds_read_b64_tr_b16 a[110:111], v10 offset:27904
    v_mfma_f32_32x32x16_bf16 v[144:159], a[68:71], a[116:119], v[144:159]
    s_waitcnt vmcnt(19) lgkmcnt(4)
    v_mfma_f32_32x32x16_bf16 v[128:143], a[72:75], a[96:99], v[128:143]
    ds_read_b64_tr_b16 a[112:113], v10 offset:28672
    ds_read_b64_tr_b16 a[114:115], v10 offset:29696
    ds_read_b64_tr_b16 a[116:117], v10 offset:28928
    ds_read_b64_tr_b16 a[118:119], v10 offset:29952
    v_mfma_f32_32x32x16_bf16 v[144:159], a[72:75], a[100:103], v[144:159]
    s_waitcnt vmcnt(18) lgkmcnt(4)
    v_mfma_f32_32x32x16_bf16 v[128:143], a[76:79], a[104:107], v[128:143]
    ds_read_b64_tr_b16 a[96:97], v10 offset:30720
    ds_read_b64_tr_b16 a[98:99], v10 offset:31744
    ds_read_b64_tr_b16 a[100:101], v10 offset:30976
    ds_read_b64_tr_b16 a[102:103], v10 offset:32000
    v_mfma_f32_32x32x16_bf16 v[144:159], a[76:79], a[108:111], v[144:159]
    s_waitcnt vmcnt(17) lgkmcnt(4)
    v_mfma_f32_32x32x16_bf16 v[128:143], a[80:83], a[112:115], v[128:143]
    ds_read_b64_tr_b16 a[104:105], v9 offset:16384
    ds_read_b64_tr_b16 a[106:107], v9 offset:17408
    ds_read_b64_tr_b16 a[108:109], v9 offset:16640
    ds_read_b64_tr_b16 a[110:111], v9 offset:17664
    v_mfma_f32_32x32x16_bf16 v[144:159], a[80:83], a[116:119], v[144:159]
    s_waitcnt vmcnt(16) lgkmcnt(4)
    v_mfma_f32_32x32x16_bf16 v[128:143], a[84:87], a[96:99], v[128:143]
    ds_read_b64_tr_b16 a[112:113], v9 offset:18432
    ds_read_b64_tr_b16 a[114:115], v9 offset:19456
    ds_read_b64_tr_b16 a[116:117], v9 offset:18688
    ds_read_b64_tr_b16 a[118:119], v9 offset:19712
    v_mfma_f32_32x32x16_bf16 v[144:159], a[84:87], a[100:103], v[144:159]
    s_waitcnt vmcnt(15) lgkmcnt(4)
    v_mfma_f32_32x32x16_bf16 v[128:143], a[88:91], a[104:107], v[128:143]
    ds_read_b64_tr_b16 a[96:97], v9 offset:20480
    ds_read_b64_tr_b16 a[98:99], v9 offset:21504
    ds_read_b64_tr_b16 a[100:101], v9 offset:20736
    ds_read_b64_tr_b16 a[102:103], v9 offset:21760
    v_mfma_f32_32x32x16_bf16 v[144:159], a[88:91], a[108:111], v[144:159]
    s_waitcnt vmcnt(14) lgkmcnt(4)
    v_mfma_f32_32x32x16_bf16 v[128:143], a[92:95], a[112:115], v[128:143]
    ds_read_b64_tr_b16 a[104:105], v9 offset:22528
    ds_read_b64_tr_b16 a[106:107], v9 offset:23552
    ds_read_b64_tr_b16 a[108:109], v9 offset:22784
    ds_read_b64_tr_b16 a[110:111], v9 offset:23808
    v_mfma_f32_32x32x16_bf16 v[144:159], a[92:95], a[116:119], v[144:159]
    s_waitcnt vmcnt(13) lgkmcnt(4)
    v_mfma_f32_32x32x16_bf16 v[128:143], a[0:3], a[96:99], v[128:143]
    ds_read_b64_tr_b16 a[112:113], v9 offset:24576
    ds_read_b64_tr_b16 a[114:115], v9 offset:25600
    ds_read_b64_tr_b16 a[116:117], v9 offset:24832
    ds_read_b64_tr_b16 a[118:119], v9 offset:25856
    v_mfma_f32_32x32x16_bf16 v[144:159], a[0:3], a[100:103], v[144:159]
    s_waitcnt vmcnt(12) lgkmcnt(4)
    v_mfma_f32_32x32x16_bf16 v[128:143], a[4:7], a[104:107], v[128:143]
    ds_read_b64_tr_b16 a[96:97], v9 offset:26624
    ds_read_b64_tr_b16 a[98:99], v9 offset:27648
    ds_read_b64_tr_b16 a[100:101], v9 offset:26880
    ds_read_b64_tr_b16 a[102:103], v9 offset:27904
    v_mfma_f32_32x32x16_bf16 v[144:159], a[4:7], a[108:111], v[144:159]
    s_waitcnt vmcnt(11) lgkmcnt(4)
    v_mfma_f32_32x32x16_bf16 v[128:143], a[8:11], a[112:115], v[128:143]
    ds_read_b64_tr_b16 a[104:105], v9 offset:28672
    ds_read_b64_tr_b16 a[106:107], v9 offset:29696
    ds_read_b64_tr_b16 a[108:109], v9 offset:28928
    ds_read_b64_tr_b16 a[110:111], v9 offset:29952
    v_mfma_f32_32x32x16_bf16 v[144:159], a[8:11], a[116:119], v[144:159]
    s_waitcnt vmcnt(10) lgkmcnt(4)
    v_mfma_f32_32x32x16_bf16 v[128:143], a[12:15], a[96:99], v[128:143]
    ds_read_b64_tr_b16 a[112:113], v9 offset:30720
    ds_read_b64_tr_b16 a[114:115], v9 offset:31744
    ds_read_b64_tr_b16 a[116:117], v9 offset:30976
    ds_read_b64_tr_b16 a[118:119], v9 offset:32000
    v_mfma_f32_32x32x16_bf16 v[144:159], a[12:15], a[100:103], v[144:159]
    s_waitcnt vmcnt(9) lgkmcnt(4)
    v_mfma_f32_32x32x16_bf16 v[128:143], a[16:19], a[104:107], v[128:143]
    s_barrier
    ds_read_b64_tr_b16 a[96:97], v10 offset:16384
    ds_read_b64_tr_b16 a[98:99], v10 offset:17408
    ds_read_b64_tr_b16 a[100:101], v10 offset:16640
    ds_read_b64_tr_b16 a[102:103], v10 offset:17664
    v_mfma_f32_32x32x16_bf16 v[144:159], a[16:19], a[108:111], v[144:159]
    s_waitcnt vmcnt(8) lgkmcnt(4)
    v_mfma_f32_32x32x16_bf16 v[128:143], a[20:23], a[112:115], v[128:143]
    ds_read_b64_tr_b16 a[104:105], v10 offset:18432
    ds_read_b64_tr_b16 a[106:107], v10 offset:19456
    ds_read_b64_tr_b16 a[108:109], v10 offset:18688
    ds_read_b64_tr_b16 a[110:111], v10 offset:19712
    v_mfma_f32_32x32x16_bf16 v[144:159], a[20:23], a[116:119], v[144:159]
    s_waitcnt vmcnt(7) lgkmcnt(4)
    v_mfma_f32_32x32x16_bf16 v[128:143], a[24:27], a[96:99], v[128:143]
    ds_read_b64_tr_b16 a[112:113], v9 offset:32768
    ds_read_b64_tr_b16 a[114:115], v9 offset:33792
    ds_read_b64_tr_b16 a[116:117], v9 offset:33024
    ds_read_b64_tr_b16 a[118:119], v9 offset:34048
    v_mfma_f32_32x32x16_bf16 v[144:159], a[24:27], a[100:103], v[144:159]
    s_waitcnt vmcnt(6) lgkmcnt(4)
    v_mfma_f32_32x32x16_bf16 v[128:143], a[28:31], a[104:107], v[128:143]
    ds_read_b64_tr_b16 a[96:97], v9 offset:34816
    ds_read_b64_tr_b16 a[98:99], v9 offset:35840
    ds_read_b64_tr_b16 a[100:101], v9 offset:35072
    ds_read_b64_tr_b16 a[102:103], v9 offset:36096
    v_mfma_f32_32x32x16_bf16 v[144:159], a[28:31], a[108:111], v[144:159]
    v_mov_b32 v3, 0
    s_mov_b64 exec, 1
    buffer_atomic_or v3, v15, s[20:23], s35 offen offset:1036 sc0 sc1
    s_mov_b64 exec, -1
    s_waitcnt vmcnt(6) lgkmcnt(4)
    v_mfma_f32_32x32x16_bf16 v[128:143], a[32:35], a[112:115], v[128:143]
    ds_read_b64_tr_b16 a[104:105], v9 offset:36864
    ds_read_b64_tr_b16 a[106:107], v9 offset:37888
    ds_read_b64_tr_b16 a[108:109], v9 offset:37120
    ds_read_b64_tr_b16 a[110:111], v9 offset:38144
    v_mfma_f32_32x32x16_bf16 v[144:159], a[32:35], a[116:119], v[144:159]
    s_waitcnt vmcnt(5) lgkmcnt(4)
    v_mfma_f32_32x32x16_bf16 v[128:143], a[36:39], a[96:99], v[128:143]
    ds_read_b64_tr_b16 a[112:113], v9 offset:38912
    ds_read_b64_tr_b16 a[114:115], v9 offset:39936
    ds_read_b64_tr_b16 a[116:117], v9 offset:39168
    ds_read_b64_tr_b16 a[118:119], v9 offset:40192
    v_mfma_f32_32x32x16_bf16 v[144:159], a[36:39], a[100:103], v[144:159]
    s_waitcnt vmcnt(4) lgkmcnt(4)
    v_mfma_f32_32x32x16_bf16 v[128:143], a[40:43], a[104:107], v[128:143]
    ds_read_b64_tr_b16 a[96:97], v9 offset:40960
    ds_read_b64_tr_b16 a[98:99], v9 offset:41984
    ds_read_b64_tr_b16 a[100:101], v9 offset:41216
    ds_read_b64_tr_b16 a[102:103], v9 offset:42240
    v_mfma_f32_32x32x16_bf16 v[144:159], a[40:43], a[108:111], v[144:159]
    s_waitcnt vmcnt(3) lgkmcnt(4)
    v_mfma_f32_32x32x16_bf16 v[128:143], a[44:47], a[112:115], v[128:143]
    ds_read_b64_tr_b16 a[104:105], v9 offset:43008
    ds_read_b64_tr_b16 a[106:107], v9 offset:44032
    ds_read_b64_tr_b16 a[108:109], v9 offset:43264
    ds_read_b64_tr_b16 a[110:111], v9 offset:44288
    v_mfma_f32_32x32x16_bf16 v[144:159], a[44:47], a[116:119], v[144:159]
    s_waitcnt vmcnt(2) lgkmcnt(4)
    v_mfma_f32_32x32x16_bf16 v[128:143], a[48:51], a[96:99], v[128:143]
    v_mfma_f32_32x32x16_bf16 v[144:159], a[48:51], a[100:103], v[144:159]
    s_waitcnt vmcnt(1) lgkmcnt(0)
    v_mfma_f32_32x32x16_bf16 v[128:143], a[52:55], a[104:107], v[128:143]
    v_mfma_f32_32x32x16_bf16 v[144:159], a[52:55], a[108:111], v[144:159]
    s_waitcnt vmcnt(0)
    v_readfirstlane_b32 s33, v3
    s_cmp_lg_u32 s33, s27
    s_cbranch_scc1 L_ynot
    buffer_load_dwordx4 v[224:227], v15, s[20:23], s34 offen offset:0 sc1
    buffer_load_dwordx4 v[228:231], v15, s[20:23], s34 offen offset:1024 sc1
    buffer_load_dwordx4 v[232:235], v15, s[20:23], s34 offen offset:2048 sc1
    buffer_load_dwordx4 v[236:239], v15, s[20:23], s34 offen offset:3072 sc1
    buffer_load_dwordx4 v[240:243], v15, s[20:23], s35 offen offset:0 sc1
    buffer_load_dwordx4 v[244:247], v15, s[20:23], s35 offen offset:1024 sc1
L_ynot:
    v_mov_b32 v60, 0xbfb8aa3b
    v_mov_b32 v61, 0xbfb8aa3b
    v_mov_b32 v62, 1.0
    v_mov_b32 v63, 1.0
    s_mov_b32 s8, s66
    s_mov_b32 s9, s67
    s_mov_b32 s10, 4194304
    s_mov_b32 s11, 0x00020000
    v_lshlrev_b32 v11, 1, v11
    s_lshl_b32 s28, s62, 1
    s_nop 3
    v_pk_mul_f32 v[32:33], v[128:129], v[60:61]
    v_pk_mul_f32 v[34:35], v[130:131], v[60:61]
    v_pk_mul_f32 v[36:37], v[132:133], v[60:61]
    v_pk_mul_f32 v[38:39], v[134:135], v[60:61]
    v_exp_f32 v32, v32
    v_exp_f32 v33, v33
    v_exp_f32 v34, v34
    v_exp_f32 v35, v35
    v_exp_f32 v36, v36
    v_exp_f32 v37, v37
    v_exp_f32 v38, v38
    v_exp_f32 v39, v39
    v_pk_add_f32 v[32:33], v[32:33], v[62:63]
    v_pk_add_f32 v[34:35], v[34:35], v[62:63]
    v_pk_add_f32 v[36:37], v[36:37], v[62:63]
    v_pk_add_f32 v[38:39], v[38:39], v[62:63]
    v_rcp_f32 v32, v32
    v_rcp_f32 v33, v33
    v_rcp_f32 v34, v34
    v_rcp_f32 v35, v35
    v_rcp_f32 v36, v36
    v_rcp_f32 v37, v37
    v_rcp_f32 v38, v38
    v_rcp_f32 v39, v39
    v_pk_mul_f32 v[128:129], v[128:129], v[32:33]
    v_pk_mul_f32 v[130:131], v[130:131], v[34:35]
    v_pk_mul_f32 v[132:133], v[132:133], v[36:37]
    v_pk_mul_f32 v[134:135], v[134:135], v[38:39]
    s_waitcnt vmcnt(0)
    v_min3_u32 v22, v227, v231, v235
    v_max3_u32 v23, v227, v231, v235
    v_min3_u32 v22, v239, v243, v22
    v_max3_u32 v23, v239, v243, v23
    v_min_u32 v22, v247, v22
    v_max_u32 v23, v247, v23
    v_xor_b32 v22, s27, v22
    v_xor_b32 v23, s27, v23
    v_or_b32 v22, v22, v23
    v_cmp_ne_u32 vcc, 0, v22
    s_cbranch_vccnz L_y_slow
L_y_ok:
    v_lshlrev_b32 v160, 16, v224
    v_and_b32 v161, 0xffff0000, v224
    v_pk_add_f32 v[160:161], v[160:161], v[192:193]
    v_pk_fma_f32 v[160:161], v[160:161], v[128:129], v[64:65]
    s_add_u32 s24, s28, 0
    buffer_store_dword v160, v11, s[8:11], s24 offen offset:0 nt
    buffer_store_dword v161, v11, s[8:11], s24 offen offset:2048 nt
    v_lshlrev_b32 v162, 16, v225
    v_and_b32 v163, 0xffff0000, v225
    v_pk_add_f32 v[162:163], v[162:163], v[194:195]
    v_pk_fma_f32 v[162:163], v[162:163], v[130:131], v[66:67]
    s_add_u32 s24, s28, 4096
    buffer_store_dword v162, v11, s[8:11], s24 offen offset:0 nt
    buffer_store_dword v163, v11, s[8:11], s24 offen offset:2048 nt
    v_lshlrev_b32 v164, 16, v226
    v_and_b32 v165, 0xffff0000, v226
    v_pk_add_f32 v[164:165], v[164:165], v[196:197]
    v_pk_fma_f32 v[164:165], v[164:165], v[132:133], v[68:69]
    s_add_u32 s24, s28, 8192
    buffer_store_dword v164, v11, s[8:11], s24 offen offset:0 nt
    buffer_store_dword v165, v11, s[8:11], s24 offen offset:2048 nt
    v_lshlrev_b32 v166, 16, v228
    v_and_b32 v167, 0xffff0000, v228
    v_pk_add_f32 v[166:167], v[166:167], v[198:199]
    v_pk_fma_f32 v[166:167], v[166:167], v[134:135], v[70:71]
    s_add_u32 s24, s28, 12288
    buffer_store_dword v166, v11, s[8:11], s24 offen offset:0 nt
    buffer_store_dword v167, v11, s[8:11], s24 offen offset:2048 nt
    v_pk_mul_f32 v[32:33], v[136:137], v[60:61]
    v_pk_mul_f32 v[34:35], v[138:139], v[60:61]
    v_pk_mul_f32 v[36:37], v[140:141], v[60:61]
    v_pk_mul_f32 v[38:39], v[142:143], v[60:61]
    v_exp_f32 v32, v32
    v_exp_f32 v33, v33
    v_exp_f32 v34, v34
    v_exp_f32 v35, v35
    v_exp_f32 v36, v36
    v_exp_f32 v37, v37
    v_exp_f32 v38, v38
    v_exp_f32 v39, v39
    v_pk_add_f32 v[32:33], v[32:33], v[62:63]
    v_pk_add_f32 v[34:35], v[34:35], v[62:63]
    v_pk_add_f32 v[36:37], v[36:37], v[62:63]
    v_pk_add_f32 v[38:39], v[38:39], v[62:63]
    v_rcp_f32 v32, v32
    v_rcp_f32 v33, v33
    v_rcp_f32 v34, v34
    v_rcp_f32 v35, v35
    v_rcp_f32 v36, v36
    v_rcp_f32 v37, v37
    v_rcp_f32 v38, v38
    v_rcp_f32 v39, v39
    v_pk_mul_f32 v[136:137], v[136:137], v[32:33]
    v_pk_mul_f32 v[138:139], v[138:139], v[34:35]
    v_pk_mul_f32 v[140:141], v[140:141], v[36:37]
    v_pk_mul_f32 v[142:143], v[142:143], v[38:39]
    v_lshlrev_b32 v168, 16, v229
    v_and_b32 v169, 0xffff0000, v229
    v_pk_add_f32 v[168:169], v[168:169], v[200:201]
    v_pk_fma_f32 v[168:169], v[168:169], v[136:137], v[72:73]
    s_add_u32 s24, s28, 16384
    buffer_store_dword v168, v11, s[8:11], s24 offen offset:0 nt
    buffer_store_dword v169, v11, s[8:11], s24 offen offset:2048 nt
    v_lshlrev_b32 v170, 16, v230
    v_and_b32 v171, 0xffff0000, v230
    v_pk_add_f32 v[170:171], v[170:171], v[202:203]
    v_pk_fma_f32 v[170:171], v[170:171], v[138:139], v[74:75]
    s_add_u32 s24, s28, 20480
    buffer_store_dword v170, v11, s[8:11], s24 offen offset:0 nt
    buffer_store_dword v171, v11, s[8:11], s24 offen offset:2048 nt
    v_lshlrev_b32 v172, 16, v232
    v_and_b32 v173, 0xffff0000, v232
    v_pk_add_f32 v[172:173], v[172:173], v[204:205]
    v_pk_fma_f32 v[172:173], v[172:173], v[140:141], v[76:77]
    s_add_u32 s24, s28, 24576
    buffer_store_dword v172, v11, s[8:11], s24 offen offset:0 nt
    buffer_store_dword v173, v11, s[8:11], s24 offen offset:2048 nt
    v_lshlrev_b32 v174, 16, v233
    v_and_b32 v175, 0xffff0000, v233
    v_pk_add_f32 v[174:175], v[174:175], v[206:207]
    v_pk_fma_f32 v[174:175], v[174:175], v[142:143], v[78:79]
    s_add_u32 s24, s28, 28672
    buffer_store_dword v174, v11, s[8:11], s24 offen offset:0 nt
    buffer_store_dword v175, v11, s[8:11], s24 offen offset:2048 nt
    v_pk_mul_f32 v[32:33], v[144:145], v[60:61]
    v_pk_mul_f32 v[34:35], v[146:147], v[60:61]
    v_pk_mul_f32 v[36:37], v[148:149], v[60:61]
    v_pk_mul_f32 v[38:39], v[150:151], v[60:61]
    v_exp_f32 v32, v32
    v_exp_f32 v33, v33
    v_exp_f32 v34, v34
    v_exp_f32 v35, v35
    v_exp_f32 v36, v36
    v_exp_f32 v37, v37
    v_exp_f32 v38, v38
    v_exp_f32 v39, v39
    v_pk_add_f32 v[32:33], v[32:33], v[62:63]
    v_pk_add_f32 v[34:35], v[34:35], v[62:63]
    v_pk_add_f32 v[36:37], v[36:37], v[62:63]
    v_pk_add_f32 v[38:39], v[38:39], v[62:63]
    v_rcp_f32 v32, v32
    v_rcp_f32 v33, v33
    v_rcp_f32 v34, v34
    v_rcp_f32 v35, v35
    v_rcp_f32 v36, v36
    v_rcp_f32 v37, v37
    v_rcp_f32 v38, v38
    v_rcp_f32 v39, v39
    v_pk_mul_f32 v[144:145], v[144:145], v[32:33]
    v_pk_mul_f32 v[146:147], v[146:147], v[34:35]
    v_pk_mul_f32 v[148:149], v[148:149], v[36:37]
    v_pk_mul_f32 v[150:151], v[150:151], v[38:39]
    v_lshlrev_b32 v176, 16, v234
    v_and_b32 v177, 0xffff0000, v234
    v_pk_add_f32 v[176:177], v[176:177], v[208:209]
    v_pk_fma_f32 v[176:177], v[176:177], v[144:145], v[80:81]
    s_add_u32 s24, s28, 0
    buffer_store_dword v176, v11, s[8:11], s24 offen offset:128 nt
    buffer_store_dword v177, v11, s[8:11], s24 offen offset:2176 nt
    v_lshlrev_b32 v178, 16, v236
    v_and_b32 v179, 0xffff0000, v236
    v_pk_add_f32 v[178:179], v[178:179], v[210:211]
    v_pk_fma_f32 v[178:179], v[178:179], v[146:147], v[82:83]
    s_add_u32 s24, s28, 4096
    buffer_store_dword v178, v11, s[8:11], s24 offen offset:128 nt
    buffer_store_dword v179, v11, s[8:11], s24 offen offset:2176 nt
    v_lshlrev_b32 v180, 16, v237
    v_and_b32 v181, 0xffff0000, v237
    v_pk_add_f32 v[180:181], v[180:181], v[212:213]
    v_pk_fma_f32 v[180:181], v[180:181], v[148:149], v[84:85]
    s_add_u32 s24, s28, 8192
    buffer_store_dword v180, v11, s[8:11], s24 offen offset:128 nt
    buffer_store_dword v181, v11, s[8:11], s24 offen offset:2176 nt
    v_lshlrev_b32 v182, 16, v238
    v_and_b32 v183, 0xffff0000, v238
    v_pk_add_f32 v[182:183], v[182:183], v[214:215]
    v_pk_fma_f32 v[182:183], v[182:183], v[150:151], v[86:87]
    s_add_u32 s24, s28, 12288
    buffer_store_dword v182, v11, s[8:11], s24 offen offset:128 nt
    buffer_store_dword v183, v11, s[8:11], s24 offen offset:2176 nt
    v_pk_mul_f32 v[32:33], v[152:153], v[60:61]
    v_pk_mul_f32 v[34:35], v[154:155], v[60:61]
    v_pk_mul_f32 v[36:37], v[156:157], v[60:61]
    v_pk_mul_f32 v[38:39], v[158:159], v[60:61]
    v_exp_f32 v32, v32
    v_exp_f32 v33, v33
    v_exp_f32 v34, v34
    v_exp_f32 v35, v35
    v_exp_f32 v36, v36
    v_exp_f32 v37, v37
    v_exp_f32 v38, v38
    v_exp_f32 v39, v39
    v_pk_add_f32 v[32:33], v[32:33], v[62:63]
    v_pk_add_f32 v[34:35], v[34:35], v[62:63]
    v_pk_add_f32 v[36:37], v[36:37], v[62:63]
    v_pk_add_f32 v[38:39], v[38:39], v[62:63]
    v_rcp_f32 v32, v32
    v_rcp_f32 v33, v33
    v_rcp_f32 v34, v34
    v_rcp_f32 v35, v35
    v_rcp_f32 v36, v36
    v_rcp_f32 v37, v37
    v_rcp_f32 v38, v38
    v_rcp_f32 v39, v39
    v_pk_mul_f32 v[152:153], v[152:153], v[32:33]
    v_pk_mul_f32 v[154:155], v[154:155], v[34:35]
    v_pk_mul_f32 v[156:157], v[156:157], v[36:37]
    v_pk_mul_f32 v[158:159], v[158:159], v[38:39]
    v_lshlrev_b32 v184, 16, v240
    v_and_b32 v185, 0xffff0000, v240
    v_pk_add_f32 v[184:185], v[184:185], v[216:217]
    v_pk_fma_f32 v[184:185], v[184:185], v[152:153], v[88:89]
    s_add_u32 s24, s28, 16384
    buffer_store_dword v184, v11, s[8:11], s24 offen offset:128 nt
    buffer_store_dword v185, v11, s[8:11], s24 offen offset:2176 nt
    v_lshlrev_b32 v186, 16, v241
    v_and_b32 v187, 0xffff0000, v241
    v_pk_add_f32 v[186:187], v[186:187], v[218:219]
    v_pk_fma_f32 v[186:187], v[186:187], v[154:155], v[90:91]
    s_add_u32 s24, s28, 20480
    buffer_store_dword v186, v11, s[8:11], s24 offen offset:128 nt
    buffer_store_dword v187, v11, s[8:11], s24 offen offset:2176 nt
    v_lshlrev_b32 v188, 16, v242
    v_and_b32 v189, 0xffff0000, v242
    v_pk_add_f32 v[188:189], v[188:189], v[220:221]
    v_pk_fma_f32 v[188:189], v[188:189], v[156:157], v[92:93]
    s_add_u32 s24, s28, 24576
    buffer_store_dword v188, v11, s[8:11], s24 offen offset:128 nt
    buffer_store_dword v189, v11, s[8:11], s24 offen offset:2176 nt
    v_lshlrev_b32 v190, 16, v244
    v_and_b32 v191, 0xffff0000, v244
    v_pk_add_f32 v[190:191], v[190:191], v[222:223]
    v_pk_fma_f32 v[190:191], v[190:191], v[158:159], v[94:95]
    s_add_u32 s24, s28, 28672
    buffer_store_dword v190, v11, s[8:11], s24 offen offset:128 nt
    buffer_store_dword v191, v11, s[8:11], s24 offen offset:2176 nt
    s_cmp_lg_u32 s97, 0
    s_cbranch_scc1 L_noep
    s_cmp_lg_u32 s32, 0
    s_cbranch_scc1 L_noep
    v_mov_b32 v20, s46
    s_mov_b64 exec, 1
    buffer_store_dword v20, v21, s[20:23], 0 offen offset:0
L_noep:
    s_endpgm
L_roleY:
    buffer_load_dwordx4 a[0:3], v15, s[20:23], s38 offen offset:0 sc1
    buffer_load_dwordx4 a[4:7], v15, s[20:23], s38 offen offset:1024 sc1
    buffer_load_dwordx4 a[8:11], v15, s[20:23], s38 offen offset:2048 sc1
    buffer_load_dwordx4 a[12:15], v15, s[20:23], s38 offen offset:3072 sc1
    s_add_u32 s38, s38, 4096
    buffer_load_dwordx4 a[16:19], v15, s[20:23], s38 offen offset:0 sc1
    buffer_load_dwordx4 a[20:23], v15, s[20:23], s38 offen offset:1024 sc1
    buffer_load_dwordx4 a[24:27], v15, s[20:23], s38 offen offset:2048 sc1
    buffer_load_dwordx4 a[28:31], v15, s[20:23], s38 offen offset:3072 sc1
    s_add_u32 s101, s101, 1
    s_and_b32 s101, s101, 7
    s_lshl_b32 s33, s101, 13
    s_add_u32 s38, s33, s45
    buffer_load_dwordx4 a[32:35], v15, s[20:23], s38 offen offset:0 sc1
    buffer_load_dwordx4 a[36:39], v15, s[20:23], s38 offen offset:1024 sc1
    ds_read_b128 a[96:99], v8 offset:32768
    ds_read_b128 a[100:103], v8 offset:40960
    ds_read_b128 a[104:107], v9 offset:32768
    ds_read_b128 a[108:111], v9 offset:40960
    s_waitcnt vmcnt(9) lgkmcnt(2)
    v_mfma_f32_32x32x16_bf16 v[128:143], a[0:3], a[96:99], 0
    ds_read_b128 a[112:115], v8 offset:36864
    ds_read_b128 a[116:119], v8 offset:45056
    v_mfma_f32_32x32x16_bf16 v[144:159], a[0:3], a[100:103], 0
    buffer_load_dwordx4 a[40:43], v15, s[20:23], s38 offen offset:2048 sc1
    buffer_load_dwordx4 a[44:47], v15, s[20:23], s38 offen offset:3072 sc1
    s_waitcnt vmcnt(10) lgkmcnt(2)
    v_mfma_f32_32x32x16_bf16 v[128:143], a[4:7], a[104:107], v[128:143]
    ds_read_b128 a[96:99], v9 offset:36864
    ds_read_b128 a[100:103], v9 offset:45056
    v_mfma_f32_32x32x16_bf16 v[144:159], a[4:7], a[108:111], v[144:159]
    s_add_u32 s38, s38, 4096
    buffer_load_dwordx4 a[48:51], v15, s[20:23], s38 offen offset:0 sc1
    buffer_load_dwordx4 a[52:55], v15, s[20:23], s38 offen offset:1024 sc1
    s_waitcnt vmcnt(11) lgkmcnt(2)
    v_mfma_f32_32x32x16_bf16 v[128:143], a[8:11], a[112:115], v[128:143]
    ds_read_b128 a[104:107], v10 offset:32768
    ds_read_b128 a[108:111], v10 offset:40960
    v_mfma_f32_32x32x16_bf16 v[144:159], a[8:11], a[116:119], v[144:159]
    buffer_load_dwordx4 a[56:59], v15, s[20:23], s38 offen offset:2048 sc1
    buffer_load_dwordx4 a[60:63], v15, s[20:23], s38 offen offset:3072 sc1
    s_waitcnt vmcnt(12) lgkmcnt(2)
    v_mfma_f32_32x32x16_bf16 v[128:143], a[12:15], a[96:99], v[128:143]
    ds_read_b128 a[112:115], v11 offset:32768
    ds_read_b128 a[116:119], v11 offset:40960
    v_mfma_f32_32x32x16_bf16 v[144:159], a[12:15], a[100:103], v[144:159]
    s_add_u32 s101, s101, 1
    s_and_b32 s101, s101, 7
    s_lshl_b32 s33, s101, 13
    s_add_u32 s38, s33, s45
    buffer_load_dwordx4 a[64:67], v15, s[20:23], s38 offen offset:0 sc1
    buffer_load_dwordx4 a[68:71], v15, s[20:23], s38 offen offset:1024 sc1
    s_waitcnt vmcnt(13) lgkmcnt(2)
    v_mfma_f32_32x32x16_bf16 v[128:143], a[16:19], a[104:107], v[128:143]
    ds_read_b128 a[96:99], v10 offset:36864
    ds_read_b128 a[100:103], v10 offset:45056
    v_mfma_f32_32x32x16_bf16 v[144:159], a[16:19], a[108:111], v[144:159]
    buffer_load_dwordx4 a[72:75], v15, s[20:23], s38 offen offset:2048 sc1
    buffer_load_dwordx4 a[76:79], v15, s[20:23], s38 offen offset:3072 sc1
    s_waitcnt vmcnt(14) lgkmcnt(2)
    v_mfma_f32_32x32x16_bf16 v[128:143], a[20:23], a[112:115], v[128:143]
    ds_read_b128 a[104:107], v11 offset:36864
    ds_read_b128 a[108:111], v11 offset:45056
    v_mfma_f32_32x32x16_bf16 v[144:159], a[20:23], a[116:119], v[144:159]
    s_add_u32 s38, s38, 4096
    buffer_load_dwordx4 a[80:83], v15, s[20:23], s38 offen offset:0 sc1
    buffer_load_dwordx4 a[84:87], v15, s[20:23], s38 offen offset:1024 sc1
    s_waitcnt vmcnt(15) lgkmcnt(2)
    v_mfma_f32_32x32x16_bf16 v[128:143], a[24:27], a[96:99], v[128:143]
    ds_read_b128 a[112:115], v8 offset:49152
    ds_read_b128 a[116:119], v8 offset:57344
    v_mfma_f32_32x32x16_bf16 v[144:159], a[24:27], a[100:103], v[144:159]
    buffer_load_dwordx4 a[88:91], v15, s[20:23], s38 offen offset:2048 sc1
    buffer_load_dwordx4 a[92:95], v15, s[20:23], s38 offen offset:3072 sc1
    s_waitcnt vmcnt(16) lgkmcnt(2)
    v_mfma_f32_32x32x16_bf16 v[128:143], a[28:31], a[104:107], v[128:143]
    ds_read_b128 a[96:99], v9 offset:49152
    ds_read_b128 a[100:103], v9 offset:57344
    v_mfma_f32_32x32x16_bf16 v[144:159], a[28:31], a[108:111], v[144:159]
    s_add_u32 s101, s101, 1
    s_and_b32 s101, s101, 7
    s_lshl_b32 s33, s101, 13
    s_add_u32 s38, s33, s45
    buffer_load_dwordx4 a[0:3], v15, s[20:23], s38 offen offset:0 sc1
    buffer_load_dwordx4 a[4:7], v15, s[20:23], s38 offen offset:1024 sc1
    s_waitcnt vmcnt(17) lgkmcnt(2)
    v_mfma_f32_32x32x16_bf16 v[128:143], a[32:35], a[112:115], v[128:143]
    ds_read_b128 a[104:107], v8 offset:53248
    ds_read_b128 a[108:111], v8 offset:61440
    v_mfma_f32_32x32x16_bf16 v[144:159], a[32:35], a[116:119], v[144:159]
    buffer_load_dwordx4 a[8:11], v15, s[20:23], s38 offen offset:2048 sc1
    buffer_load_dwordx4 a[12:15], v15, s[20:23], s38 offen offset:3072 sc1
    s_waitcnt vmcnt(18) lgkmcnt(2)
    v_mfma_f32_32x32x16_bf16 v[128:143], a[36:39], a[96:99], v[128:143]
    ds_read_b128 a[112:115], v9 offset:53248
    ds_read_b128 a[116:119], v9 offset:61440
    v_mfma_f32_32x32x16_bf16 v[144:159], a[36:39], a[100:103], v[144:159]
    s_add_u32 s38, s38, 4096
    buffer_load_dwordx4 a[16:19], v15, s[20:23], s38 offen offset:0 sc1
    buffer_load_dwordx4 a[20:23], v15, s[20:23], s38 offen offset:1024 sc1
    s_waitcnt vmcnt(19) lgkmcnt(2)
    v_mfma_f32_32x32x16_bf16 v[128:143], a[40:43], a[104:107], v[128:143]
    ds_read_b128 a[96:99], v10 offset:49152
    ds_read_b128 a[100:103], v10 offset:57344
    v_mfma_f32_32x32x16_bf16 v[144:159], a[40:43], a[108:111], v[144:159]
    buffer_load_dwordx4 a[24:27], v15, s[20:23], s38 offen offset:2048 sc1
    buffer_load_dwordx4 a[28:31], v15, s[20:23], s38 offen offset:3072 sc1
    s_waitcnt vmcnt(20) lgkmcnt(2)
    v_mfma_f32_32x32x16_bf16 v[128:143], a[44:47], a[112:115], v[128:143]
    ds_read_b128 a[104:107], v11 offset:49152
    ds_read_b128 a[108:111], v11 offset:57344
    v_mfma_f32_32x32x16_bf16 v[144:159], a[44:47], a[116:119], v[144:159]
    s_add_u32 s101, s101, 1
    s_and_b32 s101, s101, 7
    s_lshl_b32 s33, s101, 13
    s_add_u32 s38, s33, s45
    buffer_load_dwordx4 a[32:35], v15, s[20:23], s38 offen offset:0 sc1
    buffer_load_dwordx4 a[36:39], v15, s[20:23], s38 offen offset:1024 sc1
    s_waitcnt vmcnt(21) lgkmcnt(2)
    v_mfma_f32_32x32x16_bf16 v[128:143], a[48:51], a[96:99], v[128:143]
    ds_read_b128 a[112:115], v10 offset:53248
    ds_read_b128 a[116:119], v10 offset:61440
    v_mfma_f32_32x32x16_bf16 v[144:159], a[48:51], a[100:103], v[144:159]
    buffer_load_dwordx4 a[40:43], v15, s[20:23], s38 offen offset:2048 sc1
    buffer_load_dwordx4 a[44:47], v15, s[20:23], s38 offen offset:3072 sc1
    s_waitcnt vmcnt(22) lgkmcnt(2)
    v_mfma_f32_32x32x16_bf16 v[128:143], a[52:55], a[104:107], v[128:143]
    ds_read_b128 a[96:99], v11 offset:53248
    ds_read_b128 a[100:103], v11 offset:61440
    v_mfma_f32_32x32x16_bf16 v[144:159], a[52:55], a[108:111], v[144:159]
    s_add_u32 s38, s38, 4096
    buffer_load_dwordx4 a[48:51], v15, s[20:23], s38 offen offset:0 sc1
    buffer_load_dwordx4 a[52:55], v15, s[20:23], s38 offen offset:1024 sc1
    s_waitcnt vmcnt(23) lgkmcnt(2)
    v_mfma_f32_32x32x16_bf16 v[128:143], a[56:59], a[112:115], v[128:143]
    ds_read_b128 a[104:107], v16 offset:0
    ds_read_b128 a[108:111], v16 offset:8192
    v_mfma_f32_32x32x16_bf16 v[144:159], a[56:59], a[116:119], v[144:159]
    buffer_load_dwordx4 a[56:59], v15, s[20:23], s38 offen offset:2048 sc1
    s_waitcnt vmcnt(23) lgkmcnt(2)
    v_mfma_f32_32x32x16_bf16 v[128:143], a[60:63], a[96:99], v[128:143]
    ds_read_b128 a[112:115], v17 offset:0
    ds_read_b128 a[116:119], v17 offset:8192
    v_mfma_f32_32x32x16_bf16 v[144:159], a[60:63], a[100:103], v[144:159]
    buffer_load_dwordx4 a[60:63], v15, s[20:23], s38 offen offset:3072 sc1
    s_waitcnt vmcnt(23) lgkmcnt(2)
    v_mfma_f32_32x32x16_bf16 v[128:143], a[64:67], a[104:107], v[128:143]
    ds_read_b128 a[96:99], v16 offset:4096
    ds_read_b128 a[100:103], v16 offset:12288
    v_mfma_f32_32x32x16_bf16 v[144:159], a[64:67], a[108:111], v[144:159]
    s_add_u32 s101, s101, 1
    s_and_b32 s101, s101, 7
    s_lshl_b32 s33, s101, 13
    s_add_u32 s38, s33, s45
    buffer_load_dwordx4 a[64:67], v15, s[20:23], s38 offen offset:0 sc1
    s_waitcnt vmcnt(23) lgkmcnt(2)
    v_mfma_f32_32x32x16_bf16 v[128:143], a[68:71], a[112:115], v[128:143]
    ds_read_b128 a[104:107], v17 offset:4096
    ds_read_b128 a[108:111], v17 offset:12288
    v_mfma_f32_32x32x16_bf16 v[144:159], a[68:71], a[116:119], v[144:159]
    buffer_load_dwordx4 a[68:71], v15, s[20:23], s38 offen offset:1024 sc1
    s_waitcnt vmcnt(23) lgkmcnt(2)
    v_mfma_f32_32x32x16_bf16 v[128:143], a[72:75], a[96:99], v[128:143]
    ds_read_b128 a[112:115], v18 offset:0
    ds_read_b128 a[116:119], v18 offset:8192
    v_mfma_f32_32x32x16_bf16 v[144:159], a[72:75], a[100:103], v[144:159]
    buffer_load_dwordx4 a[72:75], v15, s[20:23], s38 offen offset:2048 sc1
    s_waitcnt vmcnt(23) lgkmcnt(2)
    v_mfma_f32_32x32x16_bf16 v[128:143], a[76:79], a[104:107], v[128:143]
    ds_read_b128 a[96:99], v19 offset:0
    ds_read_b128 a[100:103], v19 offset:8192
    v_mfma_f32_32x32x16_bf16 v[144:159], a[76:79], a[108:111], v[144:159]
    buffer_load_dwordx4 a[76:79], v15, s[20:23], s38 offen offset:3072 sc1
    s_waitcnt vmcnt(23) lgkmcnt(2)
    v_mfma_f32_32x32x16_bf16 v[128:143], a[80:83], a[112:115], v[128:143]
    ds_read_b128 a[104:107], v18 offset:4096
    ds_read_b128 a[108:111], v18 offset:12288
    v_mfma_f32_32x32x16_bf16 v[144:159], a[80:83], a[116:119], v[144:159]
    s_add_u32 s38, s38, 4096
    buffer_load_dwordx4 a[80:83], v15, s[20:23], s38 offen offset:0 sc1
    s_waitcnt vmcnt(23) lgkmcnt(2)
    v_mfma_f32_32x32x16_bf16 v[128:143], a[84:87], a[96:99], v[128:143]
    ds_read_b128 a[112:115], v19 offset:4096
    ds_read_b128 a[116:119], v19 offset:12288
    v_mfma_f32_32x32x16_bf16 v[144:159], a[84:87], a[100:103], v[144:159]
    buffer_load_dwordx4 a[84:87], v15, s[20:23], s38 offen offset:1024 sc1
    s_waitcnt vmcnt(23) lgkmcnt(2)
    v_mfma_f32_32x32x16_bf16 v[128:143], a[88:91], a[104:107], v[128:143]
    ds_read_b128 a[96:99], v4 offset:0
    ds_read_b128 a[100:103], v4 offset:8192
    v_mfma_f32_32x32x16_bf16 v[144:159], a[88:91], a[108:111], v[144:159]
    buffer_load_dwordx4 a[88:91], v15, s[20:23], s38 offen offset:2048 sc1
    s_waitcnt vmcnt(23) lgkmcnt(2)
    v_mfma_f32_32x32x16_bf16 v[128:143], a[92:95], a[112:115], v[128:143]
    ds_read_b128 a[104:107], v5 offset:0
    ds_read_b128 a[108:111], v5 offset:8192
    v_mfma_f32_32x32x16_bf16 v[144:159], a[92:95], a[116:119], v[144:159]
    buffer_load_dwordx4 a[92:95], v15, s[20:23], s38 offen offset:3072 sc1
    s_waitcnt vmcnt(23) lgkmcnt(2)
    v_mfma_f32_32x32x16_bf16 v[128:143], a[0:3], a[96:99], v[128:143]
    ds_read_b128 a[112:115], v4 offset:4096
    ds_read_b128 a[116:119], v4 offset:12288
    v_mfma_f32_32x32x16_bf16 v[144:159], a[0:3], a[100:103], v[144:159]
    s_add_u32 s101, s101, 1
    s_and_b32 s101, s101, 7
    s_lshl_b32 s33, s101, 13
    s_add_u32 s38, s33, s45
    buffer_load_dwordx4 a[0:3], v15, s[20:23], s38 offen offset:0 sc1
    s_waitcnt vmcnt(23) lgkmcnt(2)
    v_mfma_f32_32x32x16_bf16 v[128:143], a[4:7], a[104:107], v[128:143]
    ds_read_b128 a[96:99], v5 offset:4096
    ds_read_b128 a[100:103], v5 offset:12288
    v_mfma_f32_32x32x16_bf16 v[144:159], a[4:7], a[108:111], v[144:159]
    buffer_load_dwordx4 a[4:7], v15, s[20:23], s38 offen offset:1024 sc1
    s_waitcnt vmcnt(23) lgkmcnt(2)
    v_mfma_f32_32x32x16_bf16 v[128:143], a[8:11], a[112:115], v[128:143]
    ds_read_b128 a[104:107], v6 offset:0
    ds_read_b128 a[108:111], v6 offset:8192
    v_mfma_f32_32x32x16_bf16 v[144:159], a[8:11], a[116:119], v[144:159]
    buffer_load_dwordx4 a[8:11], v15, s[20:23], s38 offen offset:2048 sc1
    s_waitcnt vmcnt(23) lgkmcnt(2)
    v_mfma_f32_32x32x16_bf16 v[128:143], a[12:15], a[96:99], v[128:143]
    ds_read_b128 a[112:115], v7 offset:0
    ds_read_b128 a[116:119], v7 offset:8192
    v_mfma_f32_32x32x16_bf16 v[144:159], a[12:15], a[100:103], v[144:159]
    buffer_load_dwordx4 a[12:15], v15, s[20:23], s38 offen offset:3072 sc1
    s_waitcnt vmcnt(23) lgkmcnt(2)
    v_mfma_f32_32x32x16_bf16 v[128:143], a[16:19], a[104:107], v[128:143]
    ds_read_b128 a[96:99], v6 offset:4096
    ds_read_b128 a[100:103], v6 offset:12288
    v_mfma_f32_32x32x16_bf16 v[144:159], a[16:19], a[108:111], v[144:159]
    s_add_u32 s38, s38, 4096
    buffer_load_dwordx4 a[16:19], v15, s[20:23], s38 offen offset:0 sc1
    s_waitcnt vmcnt(23) lgkmcnt(2)
    v_mfma_f32_32x32x16_bf16 v[128:143], a[20:23], a[112:115], v[128:143]
    ds_read_b128 a[104:107], v7 offset:4096
    ds_read_b128 a[108:111], v7 offset:12288
    v_mfma_f32_32x32x16_bf16 v[144:159], a[20:23], a[116:119], v[144:159]
    buffer_load_dwordx4 a[20:23], v15, s[20:23], s38 offen offset:1024 sc1
    s_waitcnt vmcnt(23) lgkmcnt(2)
    v_mfma_f32_32x32x16_bf16 v[128:143], a[24:27], a[96:99], v[128:143]
    ds_read_b128 a[112:115], v4 offset:16384
    ds_read_b128 a[116:119], v4 offset:24576
    v_mfma_f32_32x32x16_bf16 v[144:159], a[24:27], a[100:103], v[144:159]
    buffer_load_dwordx4 a[24:27], v15, s[20:23], s38 offen offset:2048 sc1
    s_waitcnt vmcnt(23) lgkmcnt(2)
    v_mfma_f32_32x32x16_bf16 v[128:143], a[28:31], a[104:107], v[128:143]
    ds_read_b128 a[96:99], v5 offset:16384
    ds_read_b128 a[100:103], v5 offset:24576
    v_mfma_f32_32x32x16_bf16 v[144:159], a[28:31], a[108:111], v[144:159]
    buffer_load_dwordx4 a[28:31], v15, s[20:23], s38 offen offset:3072 sc1
    s_waitcnt vmcnt(23) lgkmcnt(2)
    v_mfma_f32_32x32x16_bf16 v[128:143], a[32:35], a[112:115], v[128:143]
    ds_read_b128 a[104:107], v4 offset:20480
    ds_read_b128 a[108:111], v4 offset:28672
    v_mfma_f32_32x32x16_bf16 v[144:159], a[32:35], a[116:119], v[144:159]
    s_add_u32 s101, s101, 1
    s_and_b32 s101, s101, 7
    s_lshl_b32 s33, s101, 13
    s_add_u32 s38, s33, s45
    buffer_load_dwordx4 a[32:35], v15, s[20:23], s38 offen offset:0 sc1
    s_waitcnt vmcnt(23) lgkmcnt(2)
    v_mfma_f32_32x32x16_bf16 v[128:143], a[36:39], a[96:99], v[128:143]
    ds_read_b128 a[112:115], v5 offset:20480
    ds_read_b128 a[116:119], v5 offset:28672
    v_mfma_f32_32x32x16_bf16 v[144:159], a[36:39], a[100:103], v[144:159]
    buffer_load_dwordx4 a[36:39], v15, s[20:23], s38 offen offset:1024 sc1
    s_waitcnt vmcnt(23) lgkmcnt(2)
    v_mfma_f32_32x32x16_bf16 v[128:143], a[40:43], a[104:107], v[128:143]
    ds_read_b128 a[96:99], v6 offset:16384
    ds_read_b128 a[100:103], v6 offset:24576
    v_mfma_f32_32x32x16_bf16 v[144:159], a[40:43], a[108:111], v[144:159]
    buffer_load_dwordx4 a[40:43], v15, s[20:23], s38 offen offset:2048 sc1
    s_waitcnt vmcnt(23) lgkmcnt(2)
    v_mfma_f32_32x32x16_bf16 v[128:143], a[44:47], a[112:115], v[128:143]
    ds_read_b128 a[104:107], v7 offset:16384
    ds_read_b128 a[108:111], v7 offset:24576
    v_mfma_f32_32x32x16_bf16 v[144:159], a[44:47], a[116:119], v[144:159]
    buffer_load_dwordx4 a[44:47], v15, s[20:23], s38 offen offset:3072 sc1
    s_waitcnt vmcnt(23) lgkmcnt(2)
    v_mfma_f32_32x32x16_bf16 v[128:143], a[48:51], a[96:99], v[128:143]
    ds_read_b128 a[112:115], v6 offset:20480
    ds_read_b128 a[116:119], v6 offset:28672
    v_mfma_f32_32x32x16_bf16 v[144:159], a[48:51], a[100:103], v[144:159]
    s_add_u32 s38, s38, 4096
    buffer_load_dwordx4 a[48:51], v15, s[20:23], s38 offen offset:0 sc1
    s_waitcnt vmcnt(23) lgkmcnt(2)
    v_mfma_f32_32x32x16_bf16 v[128:143], a[52:55], a[104:107], v[128:143]
    ds_read_b128 a[96:99], v7 offset:20480
    ds_read_b128 a[100:103], v7 offset:28672
    v_mfma_f32_32x32x16_bf16 v[144:159], a[52:55], a[108:111], v[144:159]
    buffer_load_dwordx4 a[52:55], v15, s[20:23], s38 offen offset:1024 sc1
    s_waitcnt vmcnt(23) lgkmcnt(2)
    v_mfma_f32_32x32x16_bf16 v[128:143], a[56:59], a[112:115], v[128:143]
    ds_read_b128 a[104:107], v4 offset:32768
    ds_read_b128 a[108:111], v4 offset:40960
    v_mfma_f32_32x32x16_bf16 v[144:159], a[56:59], a[116:119], v[144:159]
    buffer_load_dwordx4 a[56:59], v15, s[20:23], s38 offen offset:2048 sc1
    s_waitcnt vmcnt(23) lgkmcnt(2)
    v_mfma_f32_32x32x16_bf16 v[128:143], a[60:63], a[96:99], v[128:143]
    ds_read_b128 a[112:115], v5 offset:32768
    ds_read_b128 a[116:119], v5 offset:40960
    v_mfma_f32_32x32x16_bf16 v[144:159], a[60:63], a[100:103], v[144:159]
    buffer_load_dwordx4 a[60:63], v15, s[20:23], s38 offen offset:3072 sc1
    s_waitcnt vmcnt(23) lgkmcnt(2)
    v_mfma_f32_32x32x16_bf16 v[128:143], a[64:67], a[104:107], v[128:143]
    ds_read_b128 a[96:99], v4 offset:36864
    ds_read_b128 a[100:103], v4 offset:45056
    v_mfma_f32_32x32x16_bf16 v[144:159], a[64:67], a[108:111], v[144:159]
    s_waitcnt vmcnt(22) lgkmcnt(2)
    v_mfma_f32_32x32x16_bf16 v[128:143], a[68:71], a[112:115], v[128:143]
    ds_read_b128 a[104:107], v5 offset:36864
    ds_read_b128 a[108:111], v5 offset:45056
    v_mfma_f32_32x32x16_bf16 v[144:159], a[68:71], a[116:119], v[144:159]
    s_waitcnt vmcnt(21) lgkmcnt(2)
    v_mfma_f32_32x32x16_bf16 v[128:143], a[72:75], a[96:99], v[128:143]
    ds_read_b128 a[112:115], v6 offset:32768
    ds_read_b128 a[116:119], v6 offset:40960
    v_mfma_f32_32x32x16_bf16 v[144:159], a[72:75], a[100:103], v[144:159]
    s_waitcnt vmcnt(20) lgkmcnt(2)
    v_mfma_f32_32x32x16_bf16 v[128:143], a[76:79], a[104:107], v[128:143]
    ds_read_b128 a[96:99], v7 offset:32768
    ds_read_b128 a[100:103], v7 offset:40960
    v_mfma_f32_32x32x16_bf16 v[144:159], a[76:79], a[108:111], v[144:159]
    s_waitcnt vmcnt(19) lgkmcnt(2)
    v_mfma_f32_32x32x16_bf16 v[128:143], a[80:83], a[112:115], v[128:143]
    ds_read_b128 a[104:107], v6 offset:36864
    ds_read_b128 a[108:111], v6 offset:45056
    v_mfma_f32_32x32x16_bf16 v[144:159], a[80:83], a[116:119], v[144:159]
    s_waitcnt vmcnt(18) lgkmcnt(2)
    v_mfma_f32_32x32x16_bf16 v[128:143], a[84:87], a[96:99], v[128:143]
    ds_read_b128 a[112:115], v7 offset:36864
    ds_read_b128 a[116:119], v7 offset:45056
    v_mfma_f32_32x32x16_bf16 v[144:159], a[84:87], a[100:103], v[144:159]
    s_waitcnt vmcnt(17) lgkmcnt(2)
    v_mfma_f32_32x32x16_bf16 v[128:143], a[88:91], a[104:107], v[128:143]
    ds_read_b128 a[96:99], v4 offset:49152
    ds_read_b128 a[100:103], v4 offset:57344
    v_mfma_f32_32x32x16_bf16 v[144:159], a[88:91], a[108:111], v[144:159]
    s_waitcnt vmcnt(16) lgkmcnt(2)
    v_mfma_f32_32x32x16_bf16 v[128:143], a[92:95], a[112:115], v[128:143]
    ds_read_b128 a[104:107], v5 offset:49152
    ds_read_b128 a[108:111], v5 offset:57344
    v_mfma_f32_32x32x16_bf16 v[144:159], a[92:95], a[116:119], v[144:159]
    s_waitcnt vmcnt(15) lgkmcnt(2)
    v_mfma_f32_32x32x16_bf16 v[128:143], a[0:3], a[96:99], v[128:143]
    ds_read_b128 a[112:115], v4 offset:53248
    ds_read_b128 a[116:119], v4 offset:61440
    v_mfma_f32_32x32x16_bf16 v[144:159], a[0:3], a[100:103], v[144:159]
    s_waitcnt vmcnt(14) lgkmcnt(2)
    v_mfma_f32_32x32x16_bf16 v[128:143], a[4:7], a[104:107], v[128:143]
    ds_read_b128 a[96:99], v5 offset:53248
    ds_read_b128 a[100:103], v5 offset:61440
    v_mfma_f32_32x32x16_bf16 v[144:159], a[4:7], a[108:111], v[144:159]
    s_waitcnt vmcnt(13) lgkmcnt(2)
    v_mfma_f32_32x32x16_bf16 v[128:143], a[8:11], a[112:115], v[128:143]
    ds_read_b128 a[104:107], v6 offset:49152
    ds_read_b128 a[108:111], v6 offset:57344
    v_mfma_f32_32x32x16_bf16 v[144:159], a[8:11], a[116:119], v[144:159]
    s_waitcnt vmcnt(12) lgkmcnt(2)
    v_mfma_f32_32x32x16_bf16 v[128:143], a[12:15], a[96:99], v[128:143]
    ds_read_b128 a[112:115], v7 offset:49152
    ds_read_b128 a[116:119], v7 offset:57344
    v_mfma_f32_32x32x16_bf16 v[144:159], a[12:15], a[100:103], v[144:159]
    s_waitcnt vmcnt(11) lgkmcnt(2)
    v_mfma_f32_32x32x16_bf16 v[128:143], a[16:19], a[104:107], v[128:143]
    ds_read_b128 a[96:99], v6 offset:53248
    ds_read_b128 a[100:103], v6 offset:61440
    v_mfma_f32_32x32x16_bf16 v[144:159], a[16:19], a[108:111], v[144:159]
    s_waitcnt vmcnt(10) lgkmcnt(2)
    v_mfma_f32_32x32x16_bf16 v[128:143], a[20:23], a[112:115], v[128:143]
    ds_read_b128 a[104:107], v7 offset:53248
    ds_read_b128 a[108:111], v7 offset:61440
    v_mfma_f32_32x32x16_bf16 v[144:159], a[20:23], a[116:119], v[144:159]
    s_waitcnt vmcnt(9) lgkmcnt(2)
    v_mfma_f32_32x32x16_bf16 v[128:143], a[24:27], a[96:99], v[128:143]
    ds_read_b128 a[112:115], v8 offset:0
    ds_read_b128 a[116:119], v8 offset:8192
    v_mfma_f32_32x32x16_bf16 v[144:159], a[24:27], a[100:103], v[144:159]
    s_waitcnt vmcnt(8) lgkmcnt(2)
    v_mfma_f32_32x32x16_bf16 v[128:143], a[28:31], a[104:107], v[128:143]
    ds_read_b128 a[96:99], v9 offset:0
    ds_read_b128 a[100:103], v9 offset:8192
    v_mfma_f32_32x32x16_bf16 v[144:159], a[28:31], a[108:111], v[144:159]
    s_waitcnt vmcnt(7) lgkmcnt(2)
    v_mfma_f32_32x32x16_bf16 v[128:143], a[32:35], a[112:115], v[128:143]
    ds_read_b128 a[104:107], v8 offset:4096
    ds_read_b128 a[108:111], v8 offset:12288
    v_mfma_f32_32x32x16_bf16 v[144:159], a[32:35], a[116:119], v[144:159]
    s_waitcnt vmcnt(6) lgkmcnt(2)
    v_mfma_f32_32x32x16_bf16 v[128:143], a[36:39], a[96:99], v[128:143]
    ds_read_b128 a[112:115], v9 offset:4096
    ds_read_b128 a[116:119], v9 offset:12288
    v_mfma_f32_32x32x16_bf16 v[144:159], a[36:39], a[100:103], v[144:159]
    s_waitcnt vmcnt(5) lgkmcnt(2)
    v_mfma_f32_32x32x16_bf16 v[128:143], a[40:43], a[104:107], v[128:143]
    ds_read_b128 a[96:99], v10 offset:0
    ds_read_b128 a[100:103], v10 offset:8192
    v_mfma_f32_32x32x16_bf16 v[144:159], a[40:43], a[108:111], v[144:159]
    s_waitcnt vmcnt(4) lgkmcnt(2)
    v_mfma_f32_32x32x16_bf16 v[128:143], a[44:47], a[112:115], v[128:143]
    ds_read_b128 a[104:107], v11 offset:0
    ds_read_b128 a[108:111], v11 offset:8192
    v_mfma_f32_32x32x16_bf16 v[144:159], a[44:47], a[116:119], v[144:159]
    s_waitcnt vmcnt(3) lgkmcnt(2)
    v_mfma_f32_32x32x16_bf16 v[128:143], a[48:51], a[96:99], v[128:143]
    ds_read_b128 a[112:115], v10 offset:4096
    ds_read_b128 a[116:119], v10 offset:12288
    v_mfma_f32_32x32x16_bf16 v[144:159], a[48:51], a[100:103], v[144:159]
    s_waitcnt vmcnt(2) lgkmcnt(2)
    v_mfma_f32_32x32x16_bf16 v[128:143], a[52:55], a[104:107], v[128:143]
    ds_read_b128 a[96:99], v11 offset:4096
    ds_read_b128 a[100:103], v11 offset:12288
    v_mfma_f32_32x32x16_bf16 v[144:159], a[52:55], a[108:111], v[144:159]
    s_waitcnt vmcnt(1) lgkmcnt(2)
    v_mfma_f32_32x32x16_bf16 v[128:143], a[56:59], a[112:115], v[128:143]
    v_mfma_f32_32x32x16_bf16 v[144:159], a[56:59], a[116:119], v[144:159]
    s_waitcnt vmcnt(0) lgkmcnt(0)
    v_mfma_f32_32x32x16_bf16 v[128:143], a[60:63], a[96:99], v[128:143]
    v_mfma_f32_32x32x16_bf16 v[144:159], a[60:63], a[100:103], v[144:159]
    s_add_u32 s35, s34, 4096
    s_nop 10
    v_cvt_pk_bf16_f32 v160, v128, v129
    v_cvt_pk_bf16_f32 v161, v130, v131
    v_cvt_pk_bf16_f32 v162, v132, v133
    v_mov_b32 v163, s27
    buffer_store_dwordx4 v[160:163], v15, s[20:23], s34 offen offset:0 sc1
    v_cvt_pk_bf16_f32 v164, v134, v135
    v_cvt_pk_bf16_f32 v165, v136, v137
    v_cvt_pk_bf16_f32 v166, v138, v139
    v_mov_b32 v167, s27
    buffer_store_dwordx4 v[164:167], v15, s[20:23], s34 offen offset:1024 sc1
    v_cvt_pk_bf16_f32 v168, v140, v141
    v_cvt_pk_bf16_f32 v169, v142, v143
    v_cvt_pk_bf16_f32 v170, v144, v145
    v_mov_b32 v171, s27
    buffer_store_dwordx4 v[168:171], v15, s[20:23], s34 offen offset:2048 sc1
    v_cvt_pk_bf16_f32 v172, v146, v147
    v_cvt_pk_bf16_f32 v173, v148, v149
    v_cvt_pk_bf16_f32 v174, v150, v151
    v_mov_b32 v175, s27
    buffer_store_dwordx4 v[172:175], v15, s[20:23], s34 offen offset:3072 sc1
    v_cvt_pk_bf16_f32 v176, v152, v153
    v_cvt_pk_bf16_f32 v177, v154, v155
    v_cvt_pk_bf16_f32 v178, v156, v157
    v_mov_b32 v179, s27
    buffer_store_dwordx4 v[176:179], v15, s[20:23], s35 offen offset:0 sc1
    v_cvt_pk_bf16_f32 v180, v158, v159
    v_mov_b32 v183, s27
    buffer_store_dwordx4 v[180:183], v15, s[20:23], s35 offen offset:1024 sc1
    s_endpgm
L_cs_slow:
    s_sleep 2
    s_add_u32 s61, s3, 0
    buffer_load_dwordx4 v[96:99], v33, s[20:23], s61 offen sc1
    s_add_u32 s61, s3, 4096
    buffer_load_dwordx4 v[100:103], v33, s[20:23], s61 offen sc1
    s_add_u32 s61, s3, 8192
    buffer_load_dwordx4 v[104:107], v33, s[20:23], s61 offen sc1
    s_add_u32 s61, s3, 12288
    buffer_load_dwordx4 v[108:111], v33, s[20:23], s61 offen sc1
    buffer_load_dwordx4 v[16:19], v25, s[20:23], 0 offen sc1
    s_waitcnt vmcnt(0)
    v_min3_u32 v22, v98, v102, v19
    v_max3_u32 v23, v98, v102, v19
    v_min3_u32 v22, v106, v110, v22
    v_max3_u32 v23, v106, v110, v23
    v_xor_b32 v22, s27, v22
    v_xor_b32 v23, s27, v23
    v_or_b32 v22, v22, v23
    v_cmp_ne_u32 vcc, 0, v22
    s_cbranch_vccnz L_cs_slow
    s_branch L_cs_ok
L_skip0:
    v_readlane_b32 s40, v14, 24
    s_add_u32 m0, s96, 49152
    s_nop 3
    buffer_load_dwordx4 v13, s[72:75], s40 offen  lds
    v_readlane_b32 s41, v14, 25
    s_add_u32 m0, s96, 53248
    s_nop 3
    buffer_load_dwordx4 v13, s[76:79], s41 offen  lds
    v_readlane_b32 s42, v14, 26
    s_add_u32 m0, s96, 57344
    s_nop 3
    buffer_load_dwordx4 v13, s[72:75], s42 offen  lds
    v_readlane_b32 s43, v14, 27
    s_add_u32 m0, s96, 61440
    s_nop 3
    buffer_load_dwordx4 v13, s[76:79], s43 offen  lds
    v_readlane_b32 s40, v14, 28
    s_add_u32 m0, s96, 65536
    s_nop 3
    buffer_load_dwordx4 v13, s[72:75], s40 offen  lds
    v_readlane_b32 s41, v14, 29
    s_add_u32 m0, s96, 69632
    s_nop 3
    buffer_load_dwordx4 v13, s[76:79], s41 offen  lds
    v_readlane_b32 s42, v14, 30
    s_add_u32 m0, s96, 73728
    s_nop 3
    buffer_load_dwordx4 v13, s[72:75], s42 offen  lds
    v_readlane_b32 s43, v14, 31
    s_add_u32 m0, s96, 77824
    s_nop 3
    buffer_load_dwordx4 v13, s[76:79], s43 offen  lds
    s_branch L_skip0r
L_t_slow:
    s_sleep 2
    v_subrev_u32 v28, 0, v26
    buffer_load_dwordx4 v[160:163], v28, s[4:7], 0 offen sc1
    v_subrev_u32 v28, 1024, v26
    buffer_load_dwordx4 v[164:167], v28, s[4:7], 0 offen sc1
    v_subrev_u32 v28, 2048, v26
    buffer_load_dwordx4 v[168:171], v28, s[4:7], 0 offen sc1
    v_subrev_u32 v28, 3072, v26
    buffer_load_dwordx4 v[172:175], v28, s[4:7], 0 offen sc1
    v_subrev_u32 v28, 4096, v26
    buffer_load_dwordx4 v[176:179], v28, s[4:7], 0 offen sc1
    v_subrev_u32 v28, 5120, v26
    buffer_load_dwordx4 v[180:183], v28, s[4:7], 0 offen sc1
    v_subrev_u32 v28, 6144, v26
    buffer_load_dwordx4 v[184:187], v28, s[4:7], 0 offen sc1
    v_subrev_u32 v28, 7168, v26
    buffer_load_dwordx4 v[188:191], v28, s[4:7], 0 offen sc1
    s_waitcnt vmcnt(0)
    v_mov_b32 v29, 0
    v_cmp_eq_u32 s[48:49], s27, v162
    v_cmp_eq_u32 s[50:51], s27, v166
    v_cmp_eq_u32 s[52:53], s27, v170
    v_addc_co_u32 v29, vcc, 0, v29, s[48:49]
    v_cmp_eq_u32 s[48:49], s27, v174
    v_addc_co_u32 v29, vcc, 0, v29, s[50:51]
    v_cmp_eq_u32 s[50:51], s27, v178
    v_addc_co_u32 v29, vcc, 0, v29, s[52:53]
    v_cmp_eq_u32 s[52:53], s27, v182
    v_addc_co_u32 v29, vcc, 0, v29, s[48:49]
    v_cmp_eq_u32 s[48:49], s27, v186
    v_addc_co_u32 v29, vcc, 0, v29, s[50:51]
    v_cmp_eq_u32 s[50:51], s27, v190
    v_addc_co_u32 v29, vcc, 0, v29, s[52:53]
    s_nop 0
    v_addc_co_u32 v29, vcc, 0, v29, s[48:49]
    s_nop 0
    v_addc_co_u32 v29, vcc, 0, v29, s[50:51]
    v_cmp_ne_u32 vcc, v27, v29
    s_cbranch_vccnz L_t_slow
    s_branch L_t_ok
L_y_slow:
    s_sleep 2
    s_mov_b64 exec, 1
    v_mov_b32 v247, 0
    buffer_atomic_or v247, v15, s[20:23], s35 offen offset:1036 sc0 sc1
    s_waitcnt vmcnt(0)
    v_cmp_ne_u32 vcc, s27, v247
    s_mov_b64 exec, -1
    s_cbranch_vccnz L_y_slow
    buffer_load_dwordx4 v[224:227], v15, s[20:23], s34 offen offset:0 sc1
    buffer_load_dwordx4 v[228:231], v15, s[20:23], s34 offen offset:1024 sc1
    buffer_load_dwordx4 v[232:235], v15, s[20:23], s34 offen offset:2048 sc1
    buffer_load_dwordx4 v[236:239], v15, s[20:23], s34 offen offset:3072 sc1
    buffer_load_dwordx4 v[240:243], v15, s[20:23], s35 offen offset:0 sc1
    buffer_load_dwordx4 v[244:247], v15, s[20:23], s35 offen offset:1024 sc1
    s_waitcnt vmcnt(0)
    v_min3_u32 v22, v227, v231, v235
    v_max3_u32 v23, v227, v231, v235
    v_min3_u32 v22, v239, v243, v22
    v_max3_u32 v23, v239, v243, v23
    v_min_u32 v22, v247, v22
    v_max_u32 v23, v247, v23
    v_xor_b32 v22, s27, v22
    v_xor_b32 v23, s27, v23
    v_or_b32 v22, v22, v23
    v_cmp_ne_u32 vcc, 0, v22
    s_cbranch_vccnz L_y_slow
    s_branch L_y_ok
L_codeend:
    s_endpgm
.section .rodata,"a"
.p2align 6
.amdhsa_kernel recurrent_scan__ssm_conv_s5__glu_gated_geglu__prompt_kernel
  .amdhsa_next_free_vgpr 472
  .amdhsa_next_free_sgpr 102
  .amdhsa_accum_offset 256
  .amdhsa_group_segment_fixed_size 0
  .amdhsa_kernarg_size 128
  .amdhsa_user_sgpr_count 2
  .amdhsa_user_sgpr_kernarg_segment_ptr 1
  .amdhsa_system_sgpr_workgroup_id_x 1
  .amdhsa_float_denorm_mode_32 3
.end_amdhsa_kernel
```
